```python
import torch

def _softmax(x, axis=-1):
    return torch.softmax(x, dim=axis)
def _gelu(x):
    return torch.nn.functional.gelu(x, approximate="tanh")
def _silu(x):
    return torch.nn.functional.silu(x)
def _sigmoid(x):
    return torch.sigmoid(x)
def _layernorm(x, axis=-1, eps=1e-5):
    m = x.mean(dim=axis, keepdim=True)
    v = x.var(dim=axis, keepdim=True, unbiased=False)
    return (x - m) / torch.sqrt(v + eps)
def _scatter_add(tgt, idx, src, axis=0):
    return tgt.clone().index_add_(axis, idx, src)
def _segment_sum(src, seg, n):
    out = torch.zeros((n,) + src.shape[1:], dtype=src.dtype)
    return out.index_add_(0, seg, src)
def _pad(x, pw):
    flat = tuple(v for pair in reversed(pw) for v in pair)
    return torch.nn.functional.pad(x, flat)

kernel_name = 'gated_mix__ssm_conv_s5__dense_activation_gelu__prompt'

def setup_inputs():

    _w = (lambda a: (lambda t: t.to(torch.bfloat16) if t.is_floating_point() else t)(torch.as_tensor(a)))
    def _A_setup():
        B, S, D = 1, 2048, 512
        P = D
        Lambda_re = -0.5 * (lambda _x: torch.exp(torch.as_tensor(_x)))((lambda *s: torch.randn(*s, dtype=torch.bfloat16) * 0.2)(P))
        Lambda_im = (lambda *s: torch.randn(*s, dtype=torch.bfloat16) * 0.8)(P) * 1.0
        B_re = (lambda *s: torch.randn(*s, dtype=torch.bfloat16) * 0.2)(P, D) * (D ** -0.5)
        B_im = (lambda *s: torch.randn(*s, dtype=torch.bfloat16) * 0.2)(P, D) * (D ** -0.5)
        C_re = (lambda *s: torch.randn(*s, dtype=torch.bfloat16) * 0.2)(D, P) * (P ** -0.5)
        C_im = (lambda *s: torch.randn(*s, dtype=torch.bfloat16) * 0.2)(D, P) * (P ** -0.5)
        log_dt = (lambda *s: torch.randn(*s, dtype=torch.bfloat16) * 0.2)(P) * 0.3 - 2.0
        Dskip = (lambda *s: torch.randn(*s, dtype=torch.bfloat16) * 0.05)(D)
        return {
            "x": _w((lambda *s: torch.randn(*s, dtype=torch.bfloat16) * 0.05)(B, S, D)),
            "Lambda_re": _w(Lambda_re),
            "Lambda_im": _w(Lambda_im),
            "B_re": _w(B_re),
            "B_im": _w(B_im),
            "C_re": _w(C_re),
            "C_im": _w(C_im),
            "log_dt": _w(log_dt),
            "Dskip": _w(Dskip),
        }
    _A_in = _A_setup()

    def _B_setup():
        B, S, D, F = 1, 2048, 512, 1792
        return {
            "x": _w((lambda *s: torch.randn(*s, dtype=torch.bfloat16) * 0.05)(B, S, D)),
            "w1": _w((lambda *s: torch.randn(*s, dtype=torch.bfloat16) * 3.2)(D, F) * (D ** -0.5)),
            "b1": _w((lambda *s: torch.randn(*s, dtype=torch.bfloat16) * 3.2)(F) * 0.01),
            "w2": _w((lambda *s: torch.randn(*s, dtype=torch.bfloat16) * 0.1)(F, D) * (F ** -0.5)),
            "b2": _w((lambda *s: torch.randn(*s, dtype=torch.bfloat16) * 0.2)(D) * 0.01),
        }
    _B_in = _B_setup()

    return {
        "A_x": _A_in["x"],
        "A_Lambda_re": _A_in["Lambda_re"],
        "A_Lambda_im": _A_in["Lambda_im"],
        "A_B_re": _A_in["B_re"],
        "A_B_im": _A_in["B_im"],
        "A_C_re": _A_in["C_re"],
        "A_C_im": _A_in["C_im"],
        "A_log_dt": _A_in["log_dt"],
        "A_Dskip": _A_in["Dskip"],
        "B_x": _B_in["x"],
        "B_w1": _B_in["w1"],
        "B_b1": _B_in["b1"],
        "B_w2": _B_in["w2"],
        "B_b2": _B_in["b2"],
        "gate_w": _w((lambda *s: torch.randn(*s, dtype=torch.bfloat16) * 0.05)(512) * 16.0),
    }

def reference(A_x, A_Lambda_re, A_Lambda_im, A_B_re, A_B_im, A_C_re, A_C_im, A_log_dt, A_Dskip, B_x, B_w1, B_b1, B_w2, B_b2, gate_w):
    def _A_ref(x, Lambda_re, Lambda_im, B_re, B_im, C_re, C_im, log_dt, Dskip):
        Bsz, L, H = x.shape
        Lam = Lambda_re + 1j * Lambda_im
        Bmat = B_re + 1j * B_im
        Cmat = C_re + 1j * C_im
        dt = torch.exp(log_dt)
        Lam_bar = torch.exp(dt * Lam)
        B_bar = ((Lam_bar - 1.0) / Lam)[:, None] * Bmat
        Bu = torch.einsum("bld,pd->blp", x + 0j, B_bar)
        h = torch.zeros_like(Bu[:, 0, :])
        hs = []
        for t in range(L):
            h = Lam_bar[None, :] * h + Bu[:, t, :]
            hs.append(h)
        hseq = torch.stack(hs, 1)
        y = 2.0 * torch.einsum("blp,dp->bld", hseq, Cmat).real + x * Dskip[None, None, :]
        return y

    def _B_ref(x, w1, b1, w2, b2):
        h = torch.einsum("bsd,df->bsf", x, w1) + b1
        h = _gelu(h)
        return torch.einsum("bsf,fd->bsd", h, w2) + b2

    x = A_x
    g = _sigmoid((x * gate_w).sum(-1, keepdims=True))
    a = _A_ref(x, A_Lambda_re, A_Lambda_im, A_B_re, A_B_im, A_C_re, A_C_im, A_log_dt, A_Dskip)
    b = _B_ref(x, B_w1, B_b1, B_w2, B_b2)
    return g * a + (1 - g) * b
```

```asm
; @launch kernel=k1_kernel grid=(256,1,1) block=(512,1,1) lds=122880
; @launch kernel=k2_kernel grid=(256,1,1) block=(256,1,1) lds=0
; @launch kernel=k3_kernel grid=(256,1,1) block=(512,1,1) lds=163840
.amdgcn_target "amdgcn-amd-amdhsa--gfx950"
.text
.p2align 8
.globl k1_kernel
.type k1_kernel,@function
k1_kernel:
  s_cmp_ge_u32 s2, 256
  s_cbranch_scc1 K1_END
  s_load_dwordx2 s[24:25], s[0:1], 0
  s_load_dwordx2 s[26:27], s[0:1], 24
  s_load_dwordx2 s[28:29], s[0:1], 32
  s_load_dwordx2 s[30:31], s[0:1], 80
  s_load_dwordx2 s[32:33], s[0:1], 136
  v_lshrrev_b32 v1, 6, v0
  s_nop 0
  v_readfirstlane_b32 s34, v1
  s_lshr_b32 s57, s34, 2
  s_and_b32 s34, s34, 3
  s_and_b32 s35, s2, 7
  s_lshl_b32 s35, s35, 1
  s_lshr_b32 s36, s2, 3
  s_and_b32 s36, s36, 1
  s_add_u32 s35, s35, s36
  s_lshr_b32 s36, s2, 4
  s_waitcnt lgkmcnt(0)
  s_mov_b32 s4, s24
  s_and_b32 s5, s25, 0xffff
  s_mov_b32 s6, 2097152
  s_mov_b32 s7, 0x00020000
  s_cmp_lt_u32 s34, 2
  s_cselect_b32 s38, s26, s28
  s_cselect_b32 s39, s27, s29
  s_mov_b32 s8, s38
  s_and_b32 s9, s39, 0xffff
  s_mov_b32 s10, 524288
  s_mov_b32 s11, 0x00020000
  s_mov_b32 s16, s30
  s_and_b32 s17, s31, 0xffff
  s_mov_b32 s18, 1835008
  s_mov_b32 s19, 0x00020000
  s_mov_b32 s20, s32
  s_and_b32 s21, s33, 0xffff
  s_mov_b32 s22, 33554432
  s_mov_b32 s23, 0x00020000
  v_and_b32 v1, 63, v0
  v_lshrrev_b32 v2, 3, v1
  v_and_b32 v3, 7, v1
  v_lshrrev_b32 v4, 4, v1
  v_xor_b32 v5, v3, v4
  v_lshlrev_b32 v5, 4, v5
  v_lshl_add_u32 v10, v2, 10, v5
  v_xor_b32 v11, 64, v10
  v_and_b32 v5, 15, v1
  v_lshrrev_b32 v5, 1, v5
  v_xor_b32 v5, v5, v4
  v_lshlrev_b32 v5, 5, v5
  v_and_b32 v6, 1, v1
  v_lshl_add_u32 v5, v6, 4, v5
  s_movk_i32 s40, 3584
  v_mul_lo_u32 v6, v4, s40
  v_add_u32 v12, v5, v6
  v_xor_b32 v13, 128, v12
  s_lshl_b32 s40, s35, 17
  s_lshl_b32 s41, s34, 15
  s_add_u32 s40, s40, s41
  s_lshl_b32 s41, s36, 15
  s_and_b32 s42, s34, 1
  s_lshl_b32 s42, s42, 14
  s_add_u32 s41, s41, s42
  s_mul_i32 s42, s34, 57344
  s_mul_i32 s43, s36, 224
  s_add_u32 s42, s42, s43
  s_lshl_b32 s44, s34, 12
  s_lshl_b32 s45, s34, 11
  s_add_u32 s45, s45, 16384
  s_lshl_b32 s46, s34, 12
  s_add_u32 s46, s46, 24576
  v_and_b32 v5, 15, v1
  v_lshrrev_b32 v6, 1, v5
  v_xor_b32 v6, v6, v4
  v_lshlrev_b32 v6, 4, v6
  v_lshl_add_u32 v16, v5, 7, v6
  v_lshlrev_b32 v7, 12, v0
  s_lshl_b32 s47, s34, 12
  v_add_u32 v14, s47, v16
  v_xor_b32 v15, 64, v14
  v_add_u32 v16, 16384, v16
  v_xor_b32 v17, 64, v16
  v_lshrrev_b32 v5, 2, v1
  v_and_b32 v5, 3, v5
  v_and_b32 v6, 3, v1
  v_and_b32 v7, 1, v4
  v_lshl_add_u32 v7, v7, 2, v5
  v_lshl_add_u32 v5, v4, 3, v5
  v_lshlrev_b32 v5, 8, v5
  v_lshl_add_u32 v5, v6, 3, v5
  v_add_u32 v5, 24576, v5
  v_xor_b32 v6, 0, v7
  v_lshl_add_u32 v18, v6, 5, v5
  v_xor_b32 v6, 1, v7
  v_lshl_add_u32 v19, v6, 5, v5
  v_xor_b32 v6, 2, v7
  v_lshl_add_u32 v20, v6, 5, v5
  v_xor_b32 v6, 3, v7
  v_lshl_add_u32 v21, v6, 5, v5
  v_xor_b32 v6, 4, v7
  v_lshl_add_u32 v22, v6, 5, v5
  v_xor_b32 v6, 5, v7
  v_lshl_add_u32 v23, v6, 5, v5
  v_xor_b32 v6, 6, v7
  v_lshl_add_u32 v24, v6, 5, v5
  v_mov_b32 v136, 0
  v_mov_b32 v137, 0
  v_mov_b32 v138, 0
  v_mov_b32 v139, 0
  v_mov_b32 v140, 0
  v_mov_b32 v141, 0
  v_mov_b32 v142, 0
  v_mov_b32 v143, 0
  v_mov_b32 v144, 0
  v_mov_b32 v145, 0
  v_mov_b32 v146, 0
  v_mov_b32 v147, 0
  v_mov_b32 v148, 0
  v_mov_b32 v149, 0
  v_mov_b32 v150, 0
  v_mov_b32 v151, 0
  v_mov_b32 v152, 0
  v_mov_b32 v153, 0
  v_mov_b32 v154, 0
  v_mov_b32 v155, 0
  v_mov_b32 v156, 0
  v_mov_b32 v157, 0
  v_mov_b32 v158, 0
  v_mov_b32 v159, 0
  v_mov_b32 v160, 0
  v_mov_b32 v161, 0
  v_mov_b32 v162, 0
  v_mov_b32 v163, 0
  v_mov_b32 v164, 0
  v_mov_b32 v165, 0
  v_mov_b32 v166, 0
  v_mov_b32 v167, 0
  v_mov_b32 v168, 0
  v_mov_b32 v169, 0
  v_mov_b32 v170, 0
  v_mov_b32 v171, 0
  v_mov_b32 v172, 0
  v_mov_b32 v173, 0
  v_mov_b32 v174, 0
  v_mov_b32 v175, 0
  v_mov_b32 v176, 0
  v_mov_b32 v177, 0
  v_mov_b32 v178, 0
  v_mov_b32 v179, 0
  v_mov_b32 v180, 0
  v_mov_b32 v181, 0
  v_mov_b32 v182, 0
  v_mov_b32 v183, 0
  v_mov_b32 v184, 0
  v_mov_b32 v185, 0
  v_mov_b32 v186, 0
  v_mov_b32 v187, 0
  v_mov_b32 v188, 0
  v_mov_b32 v189, 0
  v_mov_b32 v190, 0
  v_mov_b32 v191, 0
  v_mov_b32 v192, 0
  v_mov_b32 v193, 0
  v_mov_b32 v194, 0
  v_mov_b32 v195, 0
  v_mov_b32 v196, 0
  v_mov_b32 v197, 0
  v_mov_b32 v198, 0
  v_mov_b32 v199, 0
  v_mov_b32 v200, 0
  v_mov_b32 v201, 0
  v_mov_b32 v202, 0
  v_mov_b32 v203, 0
  v_mov_b32 v204, 0
  v_mov_b32 v205, 0
  v_mov_b32 v206, 0
  v_mov_b32 v207, 0
  v_mov_b32 v208, 0
  v_mov_b32 v209, 0
  v_mov_b32 v210, 0
  v_mov_b32 v211, 0
  v_mov_b32 v212, 0
  v_mov_b32 v213, 0
  v_mov_b32 v214, 0
  v_mov_b32 v215, 0
  v_mov_b32 v216, 0
  v_mov_b32 v217, 0
  v_mov_b32 v218, 0
  v_mov_b32 v219, 0
  v_mov_b32 v220, 0
  v_mov_b32 v221, 0
  v_mov_b32 v222, 0
  v_mov_b32 v223, 0
  s_cmp_eq_u32 s57, 0
  s_cbranch_scc1 K1_COMP
  v_subrev_u32 v0, 256, v0
  s_load_dwordx2 s[24:25], s[0:1], 8
  s_load_dwordx2 s[26:27], s[0:1], 16
  s_load_dwordx2 s[28:29], s[0:1], 56
  s_waitcnt lgkmcnt(0)
  v_and_b32 v2, 31, v0
  v_lshrrev_b32 v3, 5, v0
  s_lshl_b32 s47, s36, 6
  v_lshlrev_b32 v5, 1, v2
  s_mov_b32 s8, s24
  s_and_b32 s9, s25, 0xffff
  s_mov_b32 s10, 1024
  s_mov_b32 s11, 0x00020000
  buffer_load_ushort v80, v5, s[8:11], s47 offen
  s_mov_b32 s8, s26
  s_and_b32 s9, s27, 0xffff
  s_mov_b32 s10, 1024
  s_mov_b32 s11, 0x00020000
  buffer_load_ushort v81, v5, s[8:11], s47 offen
  s_mov_b32 s8, s28
  s_and_b32 s9, s29, 0xffff
  s_mov_b32 s10, 1024
  s_mov_b32 s11, 0x00020000
  buffer_load_ushort v82, v5, s[8:11], s47 offen
  s_load_dwordx2 s[24:25], s[0:1], 112
  s_waitcnt lgkmcnt(0)
  s_mov_b32 s8, s24
  s_and_b32 s9, s25, 0xffff
  s_mov_b32 s10, 1024
  s_mov_b32 s11, 0x00020000
  v_lshlrev_b32 v5, 5, v2
  v_lshl_add_u32 v6, v3, 10, v5
  s_lshl_b32 s47, s35, 17
  s_lshl_b32 s48, s36, 13
  s_add_u32 s47, s47, s48
  buffer_load_dwordx4 v[44:47], v6, s[4:7], s47 offen
  buffer_load_dwordx4 v[48:51], v6, s[4:7], s47 offen offset:16
  buffer_load_dwordx4 v[52:55], v5, s[8:11], 0 offen
  buffer_load_dwordx4 v[56:59], v5, s[8:11], 0 offen offset:16
  s_mov_b32 s8, s38
  s_and_b32 s9, s39, 0xffff
  s_mov_b32 s10, 524288
  s_mov_b32 s11, 0x00020000
  s_add_u32 s47, s40, 0
  s_add_u32 m0, s44, 0
  s_nop 0
  buffer_load_dwordx4 v10, s[4:7], s47 offen lds
  s_add_u32 s47, s40, 8192
  s_add_u32 m0, s44, 1024
  s_nop 0
  buffer_load_dwordx4 v11, s[4:7], s47 offen lds
  s_add_u32 s47, s40, 16384
  s_add_u32 m0, s44, 2048
  s_nop 0
  buffer_load_dwordx4 v10, s[4:7], s47 offen lds
  s_add_u32 s47, s40, 24576
  s_add_u32 m0, s44, 3072
  s_nop 0
  buffer_load_dwordx4 v11, s[4:7], s47 offen lds
  s_add_u32 s47, s41, 0
  s_add_u32 m0, s45, 0
  s_nop 0
  buffer_load_dwordx4 v10, s[8:11], s47 offen lds
  s_add_u32 s47, s41, 8192
  s_add_u32 m0, s45, 1024
  s_nop 0
  buffer_load_dwordx4 v11, s[8:11], s47 offen lds
  s_add_u32 s47, s42, 0
  s_add_u32 m0, s46, 0
  s_nop 0
  buffer_load_dwordx4 v12, s[16:19], s47 offen lds
  s_add_u32 s47, s42, 14336
  s_add_u32 m0, s46, 1024
  s_nop 0
  buffer_load_dwordx4 v12, s[16:19], s47 offen lds
  s_add_u32 s47, s42, 28672
  s_add_u32 m0, s46, 2048
  s_nop 0
  buffer_load_dwordx4 v13, s[16:19], s47 offen lds
  s_add_u32 s47, s42, 43008
  s_add_u32 m0, s46, 3072
  s_nop 0
  buffer_load_dwordx4 v13, s[16:19], s47 offen lds
  s_add_u32 s47, s40, 128
  s_add_u32 m0, s44, 40960
  s_nop 0
  buffer_load_dwordx4 v10, s[4:7], s47 offen lds
  s_add_u32 s47, s40, 8320
  s_add_u32 m0, s44, 41984
  s_nop 0
  buffer_load_dwordx4 v11, s[4:7], s47 offen lds
  s_add_u32 s47, s40, 16512
  s_add_u32 m0, s44, 43008
  s_nop 0
  buffer_load_dwordx4 v10, s[4:7], s47 offen lds
  s_add_u32 s47, s40, 24704
  s_add_u32 m0, s44, 44032
  s_nop 0
  buffer_load_dwordx4 v11, s[4:7], s47 offen lds
  s_add_u32 s47, s41, 128
  s_add_u32 m0, s45, 40960
  s_nop 0
  buffer_load_dwordx4 v10, s[8:11], s47 offen lds
  s_add_u32 s47, s41, 8320
  s_add_u32 m0, s45, 41984
  s_nop 0
  buffer_load_dwordx4 v11, s[8:11], s47 offen lds
  s_add_u32 s47, s42, 229376
  s_add_u32 m0, s46, 40960
  s_nop 0
  buffer_load_dwordx4 v12, s[16:19], s47 offen lds
  s_add_u32 s47, s42, 243712
  s_add_u32 m0, s46, 41984
  s_nop 0
  buffer_load_dwordx4 v12, s[16:19], s47 offen lds
  s_add_u32 s47, s42, 258048
  s_add_u32 m0, s46, 43008
  s_nop 0
  buffer_load_dwordx4 v13, s[16:19], s47 offen lds
  s_add_u32 s47, s42, 272384
  s_add_u32 m0, s46, 44032
  s_nop 0
  buffer_load_dwordx4 v13, s[16:19], s47 offen lds
  s_waitcnt vmcnt(10)
  s_barrier
  s_add_u32 s47, s40, 256
  s_add_u32 m0, s44, 81920
  s_nop 0
  buffer_load_dwordx4 v10, s[4:7], s47 offen lds
  s_add_u32 s47, s40, 8448
  s_add_u32 m0, s44, 82944
  s_nop 0
  buffer_load_dwordx4 v11, s[4:7], s47 offen lds
  s_add_u32 s47, s40, 16640
  s_add_u32 m0, s44, 83968
  s_nop 0
  buffer_load_dwordx4 v10, s[4:7], s47 offen lds
  s_add_u32 s47, s40, 24832
  s_add_u32 m0, s44, 84992
  s_nop 0
  buffer_load_dwordx4 v11, s[4:7], s47 offen lds
  s_add_u32 s47, s41, 256
  s_add_u32 m0, s45, 81920
  s_nop 0
  buffer_load_dwordx4 v10, s[8:11], s47 offen lds
  s_add_u32 s47, s41, 8448
  s_add_u32 m0, s45, 82944
  s_nop 0
  buffer_load_dwordx4 v11, s[8:11], s47 offen lds
  s_add_u32 s47, s42, 458752
  s_add_u32 m0, s46, 81920
  s_nop 0
  buffer_load_dwordx4 v12, s[16:19], s47 offen lds
  s_add_u32 s47, s42, 473088
  s_add_u32 m0, s46, 82944
  s_nop 0
  buffer_load_dwordx4 v12, s[16:19], s47 offen lds
  s_add_u32 s47, s42, 487424
  s_add_u32 m0, s46, 83968
  s_nop 0
  buffer_load_dwordx4 v13, s[16:19], s47 offen lds
  s_add_u32 s47, s42, 501760
  s_add_u32 m0, s46, 84992
  s_nop 0
  buffer_load_dwordx4 v13, s[16:19], s47 offen lds
  s_waitcnt vmcnt(10)
  s_barrier
  s_add_u32 s47, s40, 384
  s_add_u32 m0, s44, 0
  s_nop 0
  buffer_load_dwordx4 v10, s[4:7], s47 offen lds
  s_add_u32 s47, s40, 8576
  s_add_u32 m0, s44, 1024
  s_nop 0
  buffer_load_dwordx4 v11, s[4:7], s47 offen lds
  s_add_u32 s47, s40, 16768
  s_add_u32 m0, s44, 2048
  s_nop 0
  buffer_load_dwordx4 v10, s[4:7], s47 offen lds
  s_add_u32 s47, s40, 24960
  s_add_u32 m0, s44, 3072
  s_nop 0
  buffer_load_dwordx4 v11, s[4:7], s47 offen lds
  s_add_u32 s47, s41, 384
  s_add_u32 m0, s45, 0
  s_nop 0
  buffer_load_dwordx4 v10, s[8:11], s47 offen lds
  s_add_u32 s47, s41, 8576
  s_add_u32 m0, s45, 1024
  s_nop 0
  buffer_load_dwordx4 v11, s[8:11], s47 offen lds
  s_add_u32 s47, s42, 688128
  s_add_u32 m0, s46, 0
  s_nop 0
  buffer_load_dwordx4 v12, s[16:19], s47 offen lds
  s_add_u32 s47, s42, 702464
  s_add_u32 m0, s46, 1024
  s_nop 0
  buffer_load_dwordx4 v12, s[16:19], s47 offen lds
  s_add_u32 s47, s42, 716800
  s_add_u32 m0, s46, 2048
  s_nop 0
  buffer_load_dwordx4 v13, s[16:19], s47 offen lds
  s_add_u32 s47, s42, 731136
  s_add_u32 m0, s46, 3072
  s_nop 0
  buffer_load_dwordx4 v13, s[16:19], s47 offen lds
  s_waitcnt vmcnt(10)
  s_barrier
  s_add_u32 s47, s40, 512
  s_add_u32 m0, s44, 40960
  s_nop 0
  buffer_load_dwordx4 v10, s[4:7], s47 offen lds
  s_add_u32 s47, s40, 8704
  s_add_u32 m0, s44, 41984
  s_nop 0
  buffer_load_dwordx4 v11, s[4:7], s47 offen lds
  s_add_u32 s47, s40, 16896
  s_add_u32 m0, s44, 43008
  s_nop 0
  buffer_load_dwordx4 v10, s[4:7], s47 offen lds
  s_add_u32 s47, s40, 25088
  s_add_u32 m0, s44, 44032
  s_nop 0
  buffer_load_dwordx4 v11, s[4:7], s47 offen lds
  s_add_u32 s47, s41, 512
  s_add_u32 m0, s45, 40960
  s_nop 0
  buffer_load_dwordx4 v10, s[8:11], s47 offen lds
  s_add_u32 s47, s41, 8704
  s_add_u32 m0, s45, 41984
  s_nop 0
  buffer_load_dwordx4 v11, s[8:11], s47 offen lds
  s_add_u32 s47, s42, 917504
  s_add_u32 m0, s46, 40960
  s_nop 0
  buffer_load_dwordx4 v12, s[16:19], s47 offen lds
  s_add_u32 s47, s42, 931840
  s_add_u32 m0, s46, 41984
  s_nop 0
  buffer_load_dwordx4 v12, s[16:19], s47 offen lds
  s_add_u32 s47, s42, 946176
  s_add_u32 m0, s46, 43008
  s_nop 0
  buffer_load_dwordx4 v13, s[16:19], s47 offen lds
  s_add_u32 s47, s42, 960512
  s_add_u32 m0, s46, 44032
  s_nop 0
  buffer_load_dwordx4 v13, s[16:19], s47 offen lds
  s_waitcnt vmcnt(10)
  s_barrier
  s_add_u32 s47, s40, 640
  s_add_u32 m0, s44, 81920
  s_nop 0
  buffer_load_dwordx4 v10, s[4:7], s47 offen lds
  s_add_u32 s47, s40, 8832
  s_add_u32 m0, s44, 82944
  s_nop 0
  buffer_load_dwordx4 v11, s[4:7], s47 offen lds
  s_add_u32 s47, s40, 17024
  s_add_u32 m0, s44, 83968
  s_nop 0
  buffer_load_dwordx4 v10, s[4:7], s47 offen lds
  s_add_u32 s47, s40, 25216
  s_add_u32 m0, s44, 84992
  s_nop 0
  buffer_load_dwordx4 v11, s[4:7], s47 offen lds
  s_add_u32 s47, s41, 640
  s_add_u32 m0, s45, 81920
  s_nop 0
  buffer_load_dwordx4 v10, s[8:11], s47 offen lds
  s_add_u32 s47, s41, 8832
  s_add_u32 m0, s45, 82944
  s_nop 0
  buffer_load_dwordx4 v11, s[8:11], s47 offen lds
  s_add_u32 s47, s42, 1146880
  s_add_u32 m0, s46, 81920
  s_nop 0
  buffer_load_dwordx4 v12, s[16:19], s47 offen lds
  s_add_u32 s47, s42, 1161216
  s_add_u32 m0, s46, 82944
  s_nop 0
  buffer_load_dwordx4 v12, s[16:19], s47 offen lds
  s_add_u32 s47, s42, 1175552
  s_add_u32 m0, s46, 83968
  s_nop 0
  buffer_load_dwordx4 v13, s[16:19], s47 offen lds
  s_add_u32 s47, s42, 1189888
  s_add_u32 m0, s46, 84992
  s_nop 0
  buffer_load_dwordx4 v13, s[16:19], s47 offen lds
  s_waitcnt vmcnt(10)
  s_barrier
  s_add_u32 s47, s40, 768
  s_add_u32 m0, s44, 0
  s_nop 0
  buffer_load_dwordx4 v10, s[4:7], s47 offen lds
  s_add_u32 s47, s40, 8960
  s_add_u32 m0, s44, 1024
  s_nop 0
  buffer_load_dwordx4 v11, s[4:7], s47 offen lds
  s_add_u32 s47, s40, 17152
  s_add_u32 m0, s44, 2048
  s_nop 0
  buffer_load_dwordx4 v10, s[4:7], s47 offen lds
  s_add_u32 s47, s40, 25344
  s_add_u32 m0, s44, 3072
  s_nop 0
  buffer_load_dwordx4 v11, s[4:7], s47 offen lds
  s_add_u32 s47, s41, 768
  s_add_u32 m0, s45, 0
  s_nop 0
  buffer_load_dwordx4 v10, s[8:11], s47 offen lds
  s_add_u32 s47, s41, 8960
  s_add_u32 m0, s45, 1024
  s_nop 0
  buffer_load_dwordx4 v11, s[8:11], s47 offen lds
  s_add_u32 s47, s42, 1376256
  s_add_u32 m0, s46, 0
  s_nop 0
  buffer_load_dwordx4 v12, s[16:19], s47 offen lds
  s_add_u32 s47, s42, 1390592
  s_add_u32 m0, s46, 1024
  s_nop 0
  buffer_load_dwordx4 v12, s[16:19], s47 offen lds
  s_add_u32 s47, s42, 1404928
  s_add_u32 m0, s46, 2048
  s_nop 0
  buffer_load_dwordx4 v13, s[16:19], s47 offen lds
  s_add_u32 s47, s42, 1419264
  s_add_u32 m0, s46, 3072
  s_nop 0
  buffer_load_dwordx4 v13, s[16:19], s47 offen lds
  s_waitcnt vmcnt(10)
  s_barrier
  s_add_u32 s47, s40, 896
  s_add_u32 m0, s44, 40960
  s_nop 0
  buffer_load_dwordx4 v10, s[4:7], s47 offen lds
  s_add_u32 s47, s40, 9088
  s_add_u32 m0, s44, 41984
  s_nop 0
  buffer_load_dwordx4 v11, s[4:7], s47 offen lds
  s_add_u32 s47, s40, 17280
  s_add_u32 m0, s44, 43008
  s_nop 0
  buffer_load_dwordx4 v10, s[4:7], s47 offen lds
  s_add_u32 s47, s40, 25472
  s_add_u32 m0, s44, 44032
  s_nop 0
  buffer_load_dwordx4 v11, s[4:7], s47 offen lds
  s_add_u32 s47, s41, 896
  s_add_u32 m0, s45, 40960
  s_nop 0
  buffer_load_dwordx4 v10, s[8:11], s47 offen lds
  s_add_u32 s47, s41, 9088
  s_add_u32 m0, s45, 41984
  s_nop 0
  buffer_load_dwordx4 v11, s[8:11], s47 offen lds
  s_add_u32 s47, s42, 1605632
  s_add_u32 m0, s46, 40960
  s_nop 0
  buffer_load_dwordx4 v12, s[16:19], s47 offen lds
  s_add_u32 s47, s42, 1619968
  s_add_u32 m0, s46, 41984
  s_nop 0
  buffer_load_dwordx4 v12, s[16:19], s47 offen lds
  s_add_u32 s47, s42, 1634304
  s_add_u32 m0, s46, 43008
  s_nop 0
  buffer_load_dwordx4 v13, s[16:19], s47 offen lds
  s_add_u32 s47, s42, 1648640
  s_add_u32 m0, s46, 44032
  s_nop 0
  buffer_load_dwordx4 v13, s[16:19], s47 offen lds
  s_waitcnt vmcnt(10)
  s_barrier
  s_waitcnt vmcnt(0)
  s_barrier
  s_waitcnt vmcnt(0)
  v_lshlrev_b32 v80, 16, v80
  v_lshlrev_b32 v81, 16, v81
  v_lshlrev_b32 v82, 16, v82
  v_mov_b32 v6, 0x3fb8aa3b
  v_mul_f32 v82, v82, v6
  v_exp_f32 v82, v82
  s_nop 0
  v_cvt_pk_bf16_f32 v82, v82, v82
  v_lshlrev_b32 v82, 16, v82
  v_mul_f32 v83, v82, v80
  v_mul_f32 v7, v82, v81
  v_mul_f32 v83, v83, v6
  v_mov_b32 v6, 0x3e22f983
  v_mul_f32 v7, v7, v6
  v_exp_f32 v8, v83
  v_mov_b32 v9, v7
  v_fract_f32 v9, v9
  v_cos_f32 v116, v9
  v_sin_f32 v117, v9
  s_nop 0
  v_mul_f32 v116, v116, v8
  v_mul_f32 v117, v117, v8
  v_mov_b32 v9, 0x41800000
  v_mul_f32 v8, v9, v83
  v_exp_f32 v8, v8
  v_mov_b32 v9, 0x41800000
  v_mul_f32 v9, v9, v7
  v_fract_f32 v9, v9
  v_cos_f32 v118, v9
  v_sin_f32 v119, v9
  s_nop 0
  v_mul_f32 v118, v118, v8
  v_mul_f32 v119, v119, v8
  v_mul_f32 v8, v80, v80
  v_fma_f32 v8, v81, v81, v8
  v_rcp_f32 v8, v8
  v_add_f32 v9, -1.0, v116
  v_mul_f32 v120, v9, v80
  v_fma_f32 v120, v117, v81, v120
  v_mul_f32 v121, v117, v80
  v_fma_f32 v121, -v9, v81, v121
  v_mul_f32 v120, v120, v8
  v_mul_f32 v121, v121, v8
  v_mov_b32 v8, 0
  s_waitcnt vmcnt(0)
  v_lshlrev_b32 v60, 16, v44
  v_lshlrev_b32 v61, 16, v52
  v_mul_f32 v60, v60, v61
  v_cvt_pk_bf16_f32 v60, v60, v60
  v_lshlrev_b32 v60, 16, v60
  v_add_f32 v8, v8, v60
  v_and_b32 v60, 0xffff0000, v44
  v_and_b32 v61, 0xffff0000, v52
  v_mul_f32 v60, v60, v61
  v_cvt_pk_bf16_f32 v60, v60, v60
  v_lshlrev_b32 v60, 16, v60
  v_add_f32 v8, v8, v60
  v_lshlrev_b32 v60, 16, v45
  v_lshlrev_b32 v61, 16, v53
  v_mul_f32 v60, v60, v61
  v_cvt_pk_bf16_f32 v60, v60, v60
  v_lshlrev_b32 v60, 16, v60
  v_add_f32 v8, v8, v60
  v_and_b32 v60, 0xffff0000, v45
  v_and_b32 v61, 0xffff0000, v53
  v_mul_f32 v60, v60, v61
  v_cvt_pk_bf16_f32 v60, v60, v60
  v_lshlrev_b32 v60, 16, v60
  v_add_f32 v8, v8, v60
  v_lshlrev_b32 v60, 16, v46
  v_lshlrev_b32 v61, 16, v54
  v_mul_f32 v60, v60, v61
  v_cvt_pk_bf16_f32 v60, v60, v60
  v_lshlrev_b32 v60, 16, v60
  v_add_f32 v8, v8, v60
  v_and_b32 v60, 0xffff0000, v46
  v_and_b32 v61, 0xffff0000, v54
  v_mul_f32 v60, v60, v61
  v_cvt_pk_bf16_f32 v60, v60, v60
  v_lshlrev_b32 v60, 16, v60
  v_add_f32 v8, v8, v60
  v_lshlrev_b32 v60, 16, v47
  v_lshlrev_b32 v61, 16, v55
  v_mul_f32 v60, v60, v61
  v_cvt_pk_bf16_f32 v60, v60, v60
  v_lshlrev_b32 v60, 16, v60
  v_add_f32 v8, v8, v60
  v_and_b32 v60, 0xffff0000, v47
  v_and_b32 v61, 0xffff0000, v55
  v_mul_f32 v60, v60, v61
  v_cvt_pk_bf16_f32 v60, v60, v60
  v_lshlrev_b32 v60, 16, v60
  v_add_f32 v8, v8, v60
  v_lshlrev_b32 v60, 16, v48
  v_lshlrev_b32 v61, 16, v56
  v_mul_f32 v60, v60, v61
  v_cvt_pk_bf16_f32 v60, v60, v60
  v_lshlrev_b32 v60, 16, v60
  v_add_f32 v8, v8, v60
  v_and_b32 v60, 0xffff0000, v48
  v_and_b32 v61, 0xffff0000, v56
  v_mul_f32 v60, v60, v61
  v_cvt_pk_bf16_f32 v60, v60, v60
  v_lshlrev_b32 v60, 16, v60
  v_add_f32 v8, v8, v60
  v_lshlrev_b32 v60, 16, v49
  v_lshlrev_b32 v61, 16, v57
  v_mul_f32 v60, v60, v61
  v_cvt_pk_bf16_f32 v60, v60, v60
  v_lshlrev_b32 v60, 16, v60
  v_add_f32 v8, v8, v60
  v_and_b32 v60, 0xffff0000, v49
  v_and_b32 v61, 0xffff0000, v57
  v_mul_f32 v60, v60, v61
  v_cvt_pk_bf16_f32 v60, v60, v60
  v_lshlrev_b32 v60, 16, v60
  v_add_f32 v8, v8, v60
  v_lshlrev_b32 v60, 16, v50
  v_lshlrev_b32 v61, 16, v58
  v_mul_f32 v60, v60, v61
  v_cvt_pk_bf16_f32 v60, v60, v60
  v_lshlrev_b32 v60, 16, v60
  v_add_f32 v8, v8, v60
  v_and_b32 v60, 0xffff0000, v50
  v_and_b32 v61, 0xffff0000, v58
  v_mul_f32 v60, v60, v61
  v_cvt_pk_bf16_f32 v60, v60, v60
  v_lshlrev_b32 v60, 16, v60
  v_add_f32 v8, v8, v60
  v_lshlrev_b32 v60, 16, v51
  v_lshlrev_b32 v61, 16, v59
  v_mul_f32 v60, v60, v61
  v_cvt_pk_bf16_f32 v60, v60, v60
  v_lshlrev_b32 v60, 16, v60
  v_add_f32 v8, v8, v60
  v_and_b32 v60, 0xffff0000, v51
  v_and_b32 v61, 0xffff0000, v59
  v_mul_f32 v60, v60, v61
  v_cvt_pk_bf16_f32 v60, v60, v60
  v_lshlrev_b32 v60, 16, v60
  v_add_f32 v8, v8, v60
  ds_swizzle_b32 v9, v8 offset:1055
  s_waitcnt lgkmcnt(0)
  v_add_f32 v8, v8, v9
  ds_swizzle_b32 v9, v8 offset:2079
  s_waitcnt lgkmcnt(0)
  v_add_f32 v8, v8, v9
  ds_swizzle_b32 v9, v8 offset:4127
  s_waitcnt lgkmcnt(0)
  v_add_f32 v8, v8, v9
  ds_swizzle_b32 v9, v8 offset:8223
  s_waitcnt lgkmcnt(0)
  v_add_f32 v8, v8, v9
  ds_swizzle_b32 v9, v8 offset:16415
  s_waitcnt lgkmcnt(0)
  v_add_f32 v8, v8, v9
  v_cvt_pk_bf16_f32 v8, v8, v8
  v_lshlrev_b32 v8, 16, v8
  v_mov_b32 v9, 0xbfb8aa3b
  v_mul_f32 v8, v8, v9
  v_exp_f32 v8, v8
  s_nop 0
  v_add_f32 v8, 1.0, v8
  v_rcp_f32 v8, v8
  s_nop 0
  v_cvt_pk_bf16_f32 v8, v8, v8
  v_lshlrev_b32 v8, 16, v8
  s_lshl_b32 s47, s35, 9
  s_lshl_b32 s48, s36, 5
  s_add_u32 s47, s47, s48
  s_add_u32 s47, s47, 25231360
  v_lshlrev_b32 v5, 2, v3
  v_cmp_eq_u32 vcc, 0, v2
  s_and_saveexec_b64 s[50:51], vcc
  buffer_store_dword v8, v5, s[20:23], s47 offen
  s_mov_b64 exec, s[50:51]
  s_waitcnt vmcnt(0)
  s_barrier
  s_barrier
  s_movk_i32 s48, 4352
  v_mul_lo_u32 v5, v3, s48
  v_lshl_add_u32 v5, v2, 2, v5
  ds_read_b32 v84, v5 offset:0
  ds_read_b32 v100, v5 offset:128
  ds_read_b32 v85, v5 offset:272
  ds_read_b32 v101, v5 offset:400
  ds_read_b32 v86, v5 offset:544
  ds_read_b32 v102, v5 offset:672
  ds_read_b32 v87, v5 offset:816
  ds_read_b32 v103, v5 offset:944
  ds_read_b32 v88, v5 offset:1088
  ds_read_b32 v104, v5 offset:1216
  ds_read_b32 v89, v5 offset:1360
  ds_read_b32 v105, v5 offset:1488
  ds_read_b32 v90, v5 offset:1632
  ds_read_b32 v106, v5 offset:1760
  ds_read_b32 v91, v5 offset:1904
  ds_read_b32 v107, v5 offset:2032
  ds_read_b32 v92, v5 offset:2176
  ds_read_b32 v108, v5 offset:2304
  ds_read_b32 v93, v5 offset:2448
  ds_read_b32 v109, v5 offset:2576
  ds_read_b32 v94, v5 offset:2720
  ds_read_b32 v110, v5 offset:2848
  ds_read_b32 v95, v5 offset:2992
  ds_read_b32 v111, v5 offset:3120
  ds_read_b32 v96, v5 offset:3264
  ds_read_b32 v112, v5 offset:3392
  ds_read_b32 v97, v5 offset:3536
  ds_read_b32 v113, v5 offset:3664
  ds_read_b32 v98, v5 offset:3808
  ds_read_b32 v114, v5 offset:3936
  ds_read_b32 v99, v5 offset:4080
  ds_read_b32 v115, v5 offset:4208
  s_waitcnt lgkmcnt(0)
  v_mul_f32 v8, v120, v84
  v_fma_f32 v8, -v121, v100, v8
  v_mul_f32 v9, v120, v100
  v_fma_f32 v9, v121, v84, v9
  v_mov_b32 v84, v8
  v_mov_b32 v100, v9
  v_mul_f32 v8, v120, v85
  v_fma_f32 v8, -v121, v101, v8
  v_mul_f32 v9, v120, v101
  v_fma_f32 v9, v121, v85, v9
  v_fma_f32 v8, v116, v84, v8
  v_fma_f32 v8, -v117, v100, v8
  v_fma_f32 v9, v116, v100, v9
  v_fma_f32 v9, v117, v84, v9
  v_mov_b32 v85, v8
  v_mov_b32 v101, v9
  v_mul_f32 v8, v120, v86
  v_fma_f32 v8, -v121, v102, v8
  v_mul_f32 v9, v120, v102
  v_fma_f32 v9, v121, v86, v9
  v_fma_f32 v8, v116, v85, v8
  v_fma_f32 v8, -v117, v101, v8
  v_fma_f32 v9, v116, v101, v9
  v_fma_f32 v9, v117, v85, v9
  v_mov_b32 v86, v8
  v_mov_b32 v102, v9
  v_mul_f32 v8, v120, v87
  v_fma_f32 v8, -v121, v103, v8
  v_mul_f32 v9, v120, v103
  v_fma_f32 v9, v121, v87, v9
  v_fma_f32 v8, v116, v86, v8
  v_fma_f32 v8, -v117, v102, v8
  v_fma_f32 v9, v116, v102, v9
  v_fma_f32 v9, v117, v86, v9
  v_mov_b32 v87, v8
  v_mov_b32 v103, v9
  v_mul_f32 v8, v120, v88
  v_fma_f32 v8, -v121, v104, v8
  v_mul_f32 v9, v120, v104
  v_fma_f32 v9, v121, v88, v9
  v_fma_f32 v8, v116, v87, v8
  v_fma_f32 v8, -v117, v103, v8
  v_fma_f32 v9, v116, v103, v9
  v_fma_f32 v9, v117, v87, v9
  v_mov_b32 v88, v8
  v_mov_b32 v104, v9
  v_mul_f32 v8, v120, v89
  v_fma_f32 v8, -v121, v105, v8
  v_mul_f32 v9, v120, v105
  v_fma_f32 v9, v121, v89, v9
  v_fma_f32 v8, v116, v88, v8
  v_fma_f32 v8, -v117, v104, v8
  v_fma_f32 v9, v116, v104, v9
  v_fma_f32 v9, v117, v88, v9
  v_mov_b32 v89, v8
  v_mov_b32 v105, v9
  v_mul_f32 v8, v120, v90
  v_fma_f32 v8, -v121, v106, v8
  v_mul_f32 v9, v120, v106
  v_fma_f32 v9, v121, v90, v9
  v_fma_f32 v8, v116, v89, v8
  v_fma_f32 v8, -v117, v105, v8
  v_fma_f32 v9, v116, v105, v9
  v_fma_f32 v9, v117, v89, v9
  v_mov_b32 v90, v8
  v_mov_b32 v106, v9
  v_mul_f32 v8, v120, v91
  v_fma_f32 v8, -v121, v107, v8
  v_mul_f32 v9, v120, v107
  v_fma_f32 v9, v121, v91, v9
  v_fma_f32 v8, v116, v90, v8
  v_fma_f32 v8, -v117, v106, v8
  v_fma_f32 v9, v116, v106, v9
  v_fma_f32 v9, v117, v90, v9
  v_mov_b32 v91, v8
  v_mov_b32 v107, v9
  v_mul_f32 v8, v120, v92
  v_fma_f32 v8, -v121, v108, v8
  v_mul_f32 v9, v120, v108
  v_fma_f32 v9, v121, v92, v9
  v_fma_f32 v8, v116, v91, v8
  v_fma_f32 v8, -v117, v107, v8
  v_fma_f32 v9, v116, v107, v9
  v_fma_f32 v9, v117, v91, v9
  v_mov_b32 v92, v8
  v_mov_b32 v108, v9
  v_mul_f32 v8, v120, v93
  v_fma_f32 v8, -v121, v109, v8
  v_mul_f32 v9, v120, v109
  v_fma_f32 v9, v121, v93, v9
  v_fma_f32 v8, v116, v92, v8
  v_fma_f32 v8, -v117, v108, v8
  v_fma_f32 v9, v116, v108, v9
  v_fma_f32 v9, v117, v92, v9
  v_mov_b32 v93, v8
  v_mov_b32 v109, v9
  v_mul_f32 v8, v120, v94
  v_fma_f32 v8, -v121, v110, v8
  v_mul_f32 v9, v120, v110
  v_fma_f32 v9, v121, v94, v9
  v_fma_f32 v8, v116, v93, v8
  v_fma_f32 v8, -v117, v109, v8
  v_fma_f32 v9, v116, v109, v9
  v_fma_f32 v9, v117, v93, v9
  v_mov_b32 v94, v8
  v_mov_b32 v110, v9
  v_mul_f32 v8, v120, v95
  v_fma_f32 v8, -v121, v111, v8
  v_mul_f32 v9, v120, v111
  v_fma_f32 v9, v121, v95, v9
  v_fma_f32 v8, v116, v94, v8
  v_fma_f32 v8, -v117, v110, v8
  v_fma_f32 v9, v116, v110, v9
  v_fma_f32 v9, v117, v94, v9
  v_mov_b32 v95, v8
  v_mov_b32 v111, v9
  v_mul_f32 v8, v120, v96
  v_fma_f32 v8, -v121, v112, v8
  v_mul_f32 v9, v120, v112
  v_fma_f32 v9, v121, v96, v9
  v_fma_f32 v8, v116, v95, v8
  v_fma_f32 v8, -v117, v111, v8
  v_fma_f32 v9, v116, v111, v9
  v_fma_f32 v9, v117, v95, v9
  v_mov_b32 v96, v8
  v_mov_b32 v112, v9
  v_mul_f32 v8, v120, v97
  v_fma_f32 v8, -v121, v113, v8
  v_mul_f32 v9, v120, v113
  v_fma_f32 v9, v121, v97, v9
  v_fma_f32 v8, v116, v96, v8
  v_fma_f32 v8, -v117, v112, v8
  v_fma_f32 v9, v116, v112, v9
  v_fma_f32 v9, v117, v96, v9
  v_mov_b32 v97, v8
  v_mov_b32 v113, v9
  v_mul_f32 v8, v120, v98
  v_fma_f32 v8, -v121, v114, v8
  v_mul_f32 v9, v120, v114
  v_fma_f32 v9, v121, v98, v9
  v_fma_f32 v8, v116, v97, v8
  v_fma_f32 v8, -v117, v113, v8
  v_fma_f32 v9, v116, v113, v9
  v_fma_f32 v9, v117, v97, v9
  v_mov_b32 v98, v8
  v_mov_b32 v114, v9
  v_mul_f32 v8, v120, v99
  v_fma_f32 v8, -v121, v115, v8
  v_mul_f32 v9, v120, v115
  v_fma_f32 v9, v121, v99, v9
  v_fma_f32 v8, v116, v98, v8
  v_fma_f32 v8, -v117, v114, v8
  v_fma_f32 v9, v116, v114, v9
  v_fma_f32 v9, v117, v98, v9
  v_mov_b32 v99, v8
  v_mov_b32 v115, v9
  v_mov_b32 v122, v99
  v_mov_b32 v123, v115
  v_lshlrev_b32 v5, 3, v0
  ds_write_b64 v5, v[122:123] offset:34816
  s_waitcnt lgkmcnt(0)
  s_barrier
  v_lshlrev_b32 v5, 3, v2
  ds_read_b64 v[44:45], v5 offset:34816
  ds_read_b64 v[46:47], v5 offset:35072
  ds_read_b64 v[48:49], v5 offset:35328
  ds_read_b64 v[50:51], v5 offset:35584
  ds_read_b64 v[52:53], v5 offset:35840
  ds_read_b64 v[54:55], v5 offset:36096
  ds_read_b64 v[56:57], v5 offset:36352
  v_mov_b32 v122, 0
  v_mov_b32 v123, 0
  s_waitcnt lgkmcnt(0)
  v_fma_f32 v8, v118, v122, v44
  v_fma_f32 v8, -v119, v123, v8
  v_fma_f32 v9, v118, v123, v45
  v_fma_f32 v9, v119, v122, v9
  v_cmp_lt_u32 vcc, 0, v3
  s_nop 1
  v_cndmask_b32 v122, v122, v8, vcc
  v_cndmask_b32 v123, v123, v9, vcc
  v_fma_f32 v8, v118, v122, v46
  v_fma_f32 v8, -v119, v123, v8
  v_fma_f32 v9, v118, v123, v47
  v_fma_f32 v9, v119, v122, v9
  v_cmp_lt_u32 vcc, 1, v3
  s_nop 1
  v_cndmask_b32 v122, v122, v8, vcc
  v_cndmask_b32 v123, v123, v9, vcc
  v_fma_f32 v8, v118, v122, v48
  v_fma_f32 v8, -v119, v123, v8
  v_fma_f32 v9, v118, v123, v49
  v_fma_f32 v9, v119, v122, v9
  v_cmp_lt_u32 vcc, 2, v3
  s_nop 1
  v_cndmask_b32 v122, v122, v8, vcc
  v_cndmask_b32 v123, v123, v9, vcc
  v_fma_f32 v8, v118, v122, v50
  v_fma_f32 v8, -v119, v123, v8
  v_fma_f32 v9, v118, v123, v51
  v_fma_f32 v9, v119, v122, v9
  v_cmp_lt_u32 vcc, 3, v3
  s_nop 1
  v_cndmask_b32 v122, v122, v8, vcc
  v_cndmask_b32 v123, v123, v9, vcc
  v_fma_f32 v8, v118, v122, v52
  v_fma_f32 v8, -v119, v123, v8
  v_fma_f32 v9, v118, v123, v53
  v_fma_f32 v9, v119, v122, v9
  v_cmp_lt_u32 vcc, 4, v3
  s_nop 1
  v_cndmask_b32 v122, v122, v8, vcc
  v_cndmask_b32 v123, v123, v9, vcc
  v_fma_f32 v8, v118, v122, v54
  v_fma_f32 v8, -v119, v123, v8
  v_fma_f32 v9, v118, v123, v55
  v_fma_f32 v9, v119, v122, v9
  v_cmp_lt_u32 vcc, 5, v3
  s_nop 1
  v_cndmask_b32 v122, v122, v8, vcc
  v_cndmask_b32 v123, v123, v9, vcc
  v_fma_f32 v8, v118, v122, v56
  v_fma_f32 v8, -v119, v123, v8
  v_fma_f32 v9, v118, v123, v57
  v_fma_f32 v9, v119, v122, v9
  v_cmp_lt_u32 vcc, 6, v3
  s_nop 1
  v_cndmask_b32 v122, v122, v8, vcc
  v_cndmask_b32 v123, v123, v9, vcc
  s_lshl_b32 s47, s35, 18
  s_lshl_b32 s48, s36, 7
  s_add_u32 s47, s47, s48
  s_add_u32 s48, s47, 4194304
  v_lshlrev_b32 v5, 15, v3
  v_lshl_add_u32 v5, v2, 2, v5
  v_mul_f32 v8, v116, v122
  v_fma_f32 v8, -v117, v123, v8
  v_mul_f32 v9, v116, v123
  v_fma_f32 v123, v117, v122, v9
  v_mov_b32 v122, v8
  v_add_f32 v84, v84, v122
  v_add_f32 v100, v100, v123
  buffer_store_dword v84, v5, s[20:23], s47 offen offset:0
  buffer_store_dword v100, v5, s[20:23], s48 offen offset:0
  v_mul_f32 v8, v116, v122
  v_fma_f32 v8, -v117, v123, v8
  v_mul_f32 v9, v116, v123
  v_fma_f32 v123, v117, v122, v9
  v_mov_b32 v122, v8
  v_add_f32 v85, v85, v122
  v_add_f32 v101, v101, v123
  buffer_store_dword v85, v5, s[20:23], s47 offen offset:2048
  buffer_store_dword v101, v5, s[20:23], s48 offen offset:2048
  v_mul_f32 v8, v116, v122
  v_fma_f32 v8, -v117, v123, v8
  v_mul_f32 v9, v116, v123
  v_fma_f32 v123, v117, v122, v9
  v_mov_b32 v122, v8
  v_add_f32 v86, v86, v122
  v_add_f32 v102, v102, v123
  v_add_u32 v5, 4096, v5
  buffer_store_dword v86, v5, s[20:23], s47 offen offset:0
  buffer_store_dword v102, v5, s[20:23], s48 offen offset:0
  v_mul_f32 v8, v116, v122
  v_fma_f32 v8, -v117, v123, v8
  v_mul_f32 v9, v116, v123
  v_fma_f32 v123, v117, v122, v9
  v_mov_b32 v122, v8
  v_add_f32 v87, v87, v122
  v_add_f32 v103, v103, v123
  buffer_store_dword v87, v5, s[20:23], s47 offen offset:2048
  buffer_store_dword v103, v5, s[20:23], s48 offen offset:2048
  v_mul_f32 v8, v116, v122
  v_fma_f32 v8, -v117, v123, v8
  v_mul_f32 v9, v116, v123
  v_fma_f32 v123, v117, v122, v9
  v_mov_b32 v122, v8
  v_add_f32 v88, v88, v122
  v_add_f32 v104, v104, v123
  v_add_u32 v5, 4096, v5
  buffer_store_dword v88, v5, s[20:23], s47 offen offset:0
  buffer_store_dword v104, v5, s[20:23], s48 offen offset:0
  v_mul_f32 v8, v116, v122
  v_fma_f32 v8, -v117, v123, v8
  v_mul_f32 v9, v116, v123
  v_fma_f32 v123, v117, v122, v9
  v_mov_b32 v122, v8
  v_add_f32 v89, v89, v122
  v_add_f32 v105, v105, v123
  buffer_store_dword v89, v5, s[20:23], s47 offen offset:2048
  buffer_store_dword v105, v5, s[20:23], s48 offen offset:2048
  v_mul_f32 v8, v116, v122
  v_fma_f32 v8, -v117, v123, v8
  v_mul_f32 v9, v116, v123
  v_fma_f32 v123, v117, v122, v9
  v_mov_b32 v122, v8
  v_add_f32 v90, v90, v122
  v_add_f32 v106, v106, v123
  v_add_u32 v5, 4096, v5
  buffer_store_dword v90, v5, s[20:23], s47 offen offset:0
  buffer_store_dword v106, v5, s[20:23], s48 offen offset:0
  v_mul_f32 v8, v116, v122
  v_fma_f32 v8, -v117, v123, v8
  v_mul_f32 v9, v116, v123
  v_fma_f32 v123, v117, v122, v9
  v_mov_b32 v122, v8
  v_add_f32 v91, v91, v122
  v_add_f32 v107, v107, v123
  buffer_store_dword v91, v5, s[20:23], s47 offen offset:2048
  buffer_store_dword v107, v5, s[20:23], s48 offen offset:2048
  v_mul_f32 v8, v116, v122
  v_fma_f32 v8, -v117, v123, v8
  v_mul_f32 v9, v116, v123
  v_fma_f32 v123, v117, v122, v9
  v_mov_b32 v122, v8
  v_add_f32 v92, v92, v122
  v_add_f32 v108, v108, v123
  v_add_u32 v5, 4096, v5
  buffer_store_dword v92, v5, s[20:23], s47 offen offset:0
  buffer_store_dword v108, v5, s[20:23], s48 offen offset:0
  v_mul_f32 v8, v116, v122
  v_fma_f32 v8, -v117, v123, v8
  v_mul_f32 v9, v116, v123
  v_fma_f32 v123, v117, v122, v9
  v_mov_b32 v122, v8
  v_add_f32 v93, v93, v122
  v_add_f32 v109, v109, v123
  buffer_store_dword v93, v5, s[20:23], s47 offen offset:2048
  buffer_store_dword v109, v5, s[20:23], s48 offen offset:2048
  v_mul_f32 v8, v116, v122
  v_fma_f32 v8, -v117, v123, v8
  v_mul_f32 v9, v116, v123
  v_fma_f32 v123, v117, v122, v9
  v_mov_b32 v122, v8
  v_add_f32 v94, v94, v122
  v_add_f32 v110, v110, v123
  v_add_u32 v5, 4096, v5
  buffer_store_dword v94, v5, s[20:23], s47 offen offset:0
  buffer_store_dword v110, v5, s[20:23], s48 offen offset:0
  v_mul_f32 v8, v116, v122
  v_fma_f32 v8, -v117, v123, v8
  v_mul_f32 v9, v116, v123
  v_fma_f32 v123, v117, v122, v9
  v_mov_b32 v122, v8
  v_add_f32 v95, v95, v122
  v_add_f32 v111, v111, v123
  buffer_store_dword v95, v5, s[20:23], s47 offen offset:2048
  buffer_store_dword v111, v5, s[20:23], s48 offen offset:2048
  v_mul_f32 v8, v116, v122
  v_fma_f32 v8, -v117, v123, v8
  v_mul_f32 v9, v116, v123
  v_fma_f32 v123, v117, v122, v9
  v_mov_b32 v122, v8
  v_add_f32 v96, v96, v122
  v_add_f32 v112, v112, v123
  v_add_u32 v5, 4096, v5
  buffer_store_dword v96, v5, s[20:23], s47 offen offset:0
  buffer_store_dword v112, v5, s[20:23], s48 offen offset:0
  v_mul_f32 v8, v116, v122
  v_fma_f32 v8, -v117, v123, v8
  v_mul_f32 v9, v116, v123
  v_fma_f32 v123, v117, v122, v9
  v_mov_b32 v122, v8
  v_add_f32 v97, v97, v122
  v_add_f32 v113, v113, v123
  buffer_store_dword v97, v5, s[20:23], s47 offen offset:2048
  buffer_store_dword v113, v5, s[20:23], s48 offen offset:2048
  v_mul_f32 v8, v116, v122
  v_fma_f32 v8, -v117, v123, v8
  v_mul_f32 v9, v116, v123
  v_fma_f32 v123, v117, v122, v9
  v_mov_b32 v122, v8
  v_add_f32 v98, v98, v122
  v_add_f32 v114, v114, v123
  v_add_u32 v5, 4096, v5
  buffer_store_dword v98, v5, s[20:23], s47 offen offset:0
  buffer_store_dword v114, v5, s[20:23], s48 offen offset:0
  v_mul_f32 v8, v116, v122
  v_fma_f32 v8, -v117, v123, v8
  v_mul_f32 v9, v116, v123
  v_fma_f32 v123, v117, v122, v9
  v_mov_b32 v122, v8
  v_add_f32 v99, v99, v122
  v_add_f32 v115, v115, v123
  buffer_store_dword v99, v5, s[20:23], s47 offen offset:2048
  buffer_store_dword v115, v5, s[20:23], s48 offen offset:2048
  v_mov_b32 v122, v99
  v_mov_b32 v123, v115
  s_lshl_b32 s47, s35, 12
  s_lshl_b32 s48, s36, 8
  s_add_u32 s47, s47, s48
  s_add_u32 s47, s47, 25165824
  v_lshlrev_b32 v5, 3, v2
  v_cmp_eq_u32 vcc, 7, v3
  s_and_saveexec_b64 s[50:51], vcc
  buffer_store_dwordx2 v[122:123], v5, s[20:23], s47 offen
  s_mov_b64 exec, s[50:51]
  s_endpgm
K1_COMP:
  s_load_dwordx2 s[24:25], s[0:1], 88
  s_waitcnt lgkmcnt(0)
  s_mov_b32 s8, s24
  s_and_b32 s9, s25, 0xffff
  s_mov_b32 s10, 3584
  s_mov_b32 s11, 0x00020000
  s_mul_i32 s47, s36, 224
  v_and_b32 v6, 15, v1
  v_lshlrev_b32 v5, 1, v6
  buffer_load_ushort v224, v5, s[8:11], s47 offen offset:0
  buffer_load_ushort v225, v5, s[8:11], s47 offen offset:32
  buffer_load_ushort v226, v5, s[8:11], s47 offen offset:64
  buffer_load_ushort v227, v5, s[8:11], s47 offen offset:96
  buffer_load_ushort v228, v5, s[8:11], s47 offen offset:128
  buffer_load_ushort v229, v5, s[8:11], s47 offen offset:160
  buffer_load_ushort v230, v5, s[8:11], s47 offen offset:192
  s_barrier
  ds_read_b128 v[32:35], v14 offset:0
  ds_read_b128 v[36:39], v14 offset:2048
  ds_read_b128 v[40:43], v16 offset:0
  ds_read_b128 v[44:47], v16 offset:2048
  ds_read_b128 v[48:51], v16 offset:4096
  ds_read_b128 v[52:55], v16 offset:6144
  ds_read_b64_tr_b16 v[56:57], v18 offset:0
  ds_read_b64_tr_b16 v[58:59], v18 offset:1024
  ds_read_b64_tr_b16 v[60:61], v19 offset:0
  ds_read_b64_tr_b16 v[62:63], v19 offset:1024
  ds_read_b64_tr_b16 v[64:65], v20 offset:0
  ds_read_b64_tr_b16 v[66:67], v20 offset:1024
  ds_read_b64_tr_b16 v[68:69], v21 offset:0
  ds_read_b64_tr_b16 v[70:71], v21 offset:1024
  ds_read_b64_tr_b16 v[72:73], v22 offset:0
  ds_read_b64_tr_b16 v[74:75], v22 offset:1024
  ds_read_b64_tr_b16 v[76:77], v23 offset:0
  ds_read_b64_tr_b16 v[78:79], v23 offset:1024
  ds_read_b64_tr_b16 v[80:81], v24 offset:0
  ds_read_b64_tr_b16 v[82:83], v24 offset:1024
  s_waitcnt lgkmcnt(0)
  ds_read_b128 v[84:87], v15 offset:0
  ds_read_b128 v[88:91], v15 offset:2048
  ds_read_b128 v[92:95], v17 offset:0
  ds_read_b128 v[96:99], v17 offset:2048
  ds_read_b128 v[100:103], v17 offset:4096
  ds_read_b128 v[104:107], v17 offset:6144
  ds_read_b64_tr_b16 v[108:109], v18 offset:8192
  ds_read_b64_tr_b16 v[110:111], v18 offset:9216
  ds_read_b64_tr_b16 v[112:113], v19 offset:8192
  ds_read_b64_tr_b16 v[114:115], v19 offset:9216
  ds_read_b64_tr_b16 v[116:117], v20 offset:8192
  ds_read_b64_tr_b16 v[118:119], v20 offset:9216
  ds_read_b64_tr_b16 v[120:121], v21 offset:8192
  ds_read_b64_tr_b16 v[122:123], v21 offset:9216
  ds_read_b64_tr_b16 v[124:125], v22 offset:8192
  ds_read_b64_tr_b16 v[126:127], v22 offset:9216
  ds_read_b64_tr_b16 v[128:129], v23 offset:8192
  ds_read_b64_tr_b16 v[130:131], v23 offset:9216
  ds_read_b64_tr_b16 v[132:133], v24 offset:8192
  ds_read_b64_tr_b16 v[134:135], v24 offset:9216
  v_mfma_f32_16x16x32_bf16 v[136:139], v[32:35], v[40:43], v[136:139]
  v_mfma_f32_16x16x32_bf16 v[180:183], v[36:39], v[40:43], v[180:183]
  v_mfma_f32_16x16x32_bf16 v[140:143], v[32:35], v[44:47], v[140:143]
  v_mfma_f32_16x16x32_bf16 v[184:187], v[36:39], v[44:47], v[184:187]
  v_mfma_f32_16x16x32_bf16 v[144:147], v[32:35], v[48:51], v[144:147]
  v_mfma_f32_16x16x32_bf16 v[188:191], v[36:39], v[48:51], v[188:191]
  v_mfma_f32_16x16x32_bf16 v[148:151], v[32:35], v[52:55], v[148:151]
  v_mfma_f32_16x16x32_bf16 v[192:195], v[36:39], v[52:55], v[192:195]
  v_mfma_f32_16x16x32_bf16 v[152:155], v[32:35], v[56:59], v[152:155]
  v_mfma_f32_16x16x32_bf16 v[196:199], v[36:39], v[56:59], v[196:199]
  v_mfma_f32_16x16x32_bf16 v[156:159], v[32:35], v[60:63], v[156:159]
  v_mfma_f32_16x16x32_bf16 v[200:203], v[36:39], v[60:63], v[200:203]
  v_mfma_f32_16x16x32_bf16 v[160:163], v[32:35], v[64:67], v[160:163]
  v_mfma_f32_16x16x32_bf16 v[204:207], v[36:39], v[64:67], v[204:207]
  v_mfma_f32_16x16x32_bf16 v[164:167], v[32:35], v[68:71], v[164:167]
  v_mfma_f32_16x16x32_bf16 v[208:211], v[36:39], v[68:71], v[208:211]
  v_mfma_f32_16x16x32_bf16 v[168:171], v[32:35], v[72:75], v[168:171]
  v_mfma_f32_16x16x32_bf16 v[212:215], v[36:39], v[72:75], v[212:215]
  v_mfma_f32_16x16x32_bf16 v[172:175], v[32:35], v[76:79], v[172:175]
  v_mfma_f32_16x16x32_bf16 v[216:219], v[36:39], v[76:79], v[216:219]
  v_mfma_f32_16x16x32_bf16 v[176:179], v[32:35], v[80:83], v[176:179]
  v_mfma_f32_16x16x32_bf16 v[220:223], v[36:39], v[80:83], v[220:223]
  s_waitcnt lgkmcnt(0)
  s_barrier
  v_add_u32 v14, 40960, v14
  v_add_u32 v15, 40960, v15
  v_add_u32 v16, 40960, v16
  v_add_u32 v17, 40960, v17
  v_add_u32 v18, 40960, v18
  v_add_u32 v19, 40960, v19
  v_add_u32 v20, 40960, v20
  v_add_u32 v21, 40960, v21
  v_add_u32 v22, 40960, v22
  v_add_u32 v23, 40960, v23
  v_add_u32 v24, 40960, v24
  ds_read_b128 v[32:35], v14 offset:0
  ds_read_b128 v[36:39], v14 offset:2048
  ds_read_b128 v[40:43], v16 offset:0
  ds_read_b128 v[44:47], v16 offset:2048
  ds_read_b128 v[48:51], v16 offset:4096
  ds_read_b128 v[52:55], v16 offset:6144
  ds_read_b64_tr_b16 v[56:57], v18 offset:0
  ds_read_b64_tr_b16 v[58:59], v18 offset:1024
  ds_read_b64_tr_b16 v[60:61], v19 offset:0
  ds_read_b64_tr_b16 v[62:63], v19 offset:1024
  ds_read_b64_tr_b16 v[64:65], v20 offset:0
  ds_read_b64_tr_b16 v[66:67], v20 offset:1024
  ds_read_b64_tr_b16 v[68:69], v21 offset:0
  ds_read_b64_tr_b16 v[70:71], v21 offset:1024
  ds_read_b64_tr_b16 v[72:73], v22 offset:0
  ds_read_b64_tr_b16 v[74:75], v22 offset:1024
  ds_read_b64_tr_b16 v[76:77], v23 offset:0
  ds_read_b64_tr_b16 v[78:79], v23 offset:1024
  ds_read_b64_tr_b16 v[80:81], v24 offset:0
  ds_read_b64_tr_b16 v[82:83], v24 offset:1024
  v_mfma_f32_16x16x32_bf16 v[136:139], v[84:87], v[92:95], v[136:139]
  v_mfma_f32_16x16x32_bf16 v[180:183], v[88:91], v[92:95], v[180:183]
  v_mfma_f32_16x16x32_bf16 v[140:143], v[84:87], v[96:99], v[140:143]
  v_mfma_f32_16x16x32_bf16 v[184:187], v[88:91], v[96:99], v[184:187]
  v_mfma_f32_16x16x32_bf16 v[144:147], v[84:87], v[100:103], v[144:147]
  v_mfma_f32_16x16x32_bf16 v[188:191], v[88:91], v[100:103], v[188:191]
  v_mfma_f32_16x16x32_bf16 v[148:151], v[84:87], v[104:107], v[148:151]
  v_mfma_f32_16x16x32_bf16 v[192:195], v[88:91], v[104:107], v[192:195]
  v_mfma_f32_16x16x32_bf16 v[152:155], v[84:87], v[108:111], v[152:155]
  v_mfma_f32_16x16x32_bf16 v[196:199], v[88:91], v[108:111], v[196:199]
  v_mfma_f32_16x16x32_bf16 v[156:159], v[84:87], v[112:115], v[156:159]
  v_mfma_f32_16x16x32_bf16 v[200:203], v[88:91], v[112:115], v[200:203]
  v_mfma_f32_16x16x32_bf16 v[160:163], v[84:87], v[116:119], v[160:163]
  v_mfma_f32_16x16x32_bf16 v[204:207], v[88:91], v[116:119], v[204:207]
  v_mfma_f32_16x16x32_bf16 v[164:167], v[84:87], v[120:123], v[164:167]
  v_mfma_f32_16x16x32_bf16 v[208:211], v[88:91], v[120:123], v[208:211]
  v_mfma_f32_16x16x32_bf16 v[168:171], v[84:87], v[124:127], v[168:171]
  v_mfma_f32_16x16x32_bf16 v[212:215], v[88:91], v[124:127], v[212:215]
  v_mfma_f32_16x16x32_bf16 v[172:175], v[84:87], v[128:131], v[172:175]
  v_mfma_f32_16x16x32_bf16 v[216:219], v[88:91], v[128:131], v[216:219]
  v_mfma_f32_16x16x32_bf16 v[176:179], v[84:87], v[132:135], v[176:179]
  v_mfma_f32_16x16x32_bf16 v[220:223], v[88:91], v[132:135], v[220:223]
  s_waitcnt lgkmcnt(0)
  ds_read_b128 v[84:87], v15 offset:0
  ds_read_b128 v[88:91], v15 offset:2048
  ds_read_b128 v[92:95], v17 offset:0
  ds_read_b128 v[96:99], v17 offset:2048
  ds_read_b128 v[100:103], v17 offset:4096
  ds_read_b128 v[104:107], v17 offset:6144
  ds_read_b64_tr_b16 v[108:109], v18 offset:8192
  ds_read_b64_tr_b16 v[110:111], v18 offset:9216
  ds_read_b64_tr_b16 v[112:113], v19 offset:8192
  ds_read_b64_tr_b16 v[114:115], v19 offset:9216
  ds_read_b64_tr_b16 v[116:117], v20 offset:8192
  ds_read_b64_tr_b16 v[118:119], v20 offset:9216
  ds_read_b64_tr_b16 v[120:121], v21 offset:8192
  ds_read_b64_tr_b16 v[122:123], v21 offset:9216
  ds_read_b64_tr_b16 v[124:125], v22 offset:8192
  ds_read_b64_tr_b16 v[126:127], v22 offset:9216
  ds_read_b64_tr_b16 v[128:129], v23 offset:8192
  ds_read_b64_tr_b16 v[130:131], v23 offset:9216
  ds_read_b64_tr_b16 v[132:133], v24 offset:8192
  ds_read_b64_tr_b16 v[134:135], v24 offset:9216
  v_mfma_f32_16x16x32_bf16 v[136:139], v[32:35], v[40:43], v[136:139]
  v_mfma_f32_16x16x32_bf16 v[180:183], v[36:39], v[40:43], v[180:183]
  v_mfma_f32_16x16x32_bf16 v[140:143], v[32:35], v[44:47], v[140:143]
  v_mfma_f32_16x16x32_bf16 v[184:187], v[36:39], v[44:47], v[184:187]
  v_mfma_f32_16x16x32_bf16 v[144:147], v[32:35], v[48:51], v[144:147]
  v_mfma_f32_16x16x32_bf16 v[188:191], v[36:39], v[48:51], v[188:191]
  v_mfma_f32_16x16x32_bf16 v[148:151], v[32:35], v[52:55], v[148:151]
  v_mfma_f32_16x16x32_bf16 v[192:195], v[36:39], v[52:55], v[192:195]
  v_mfma_f32_16x16x32_bf16 v[152:155], v[32:35], v[56:59], v[152:155]
  v_mfma_f32_16x16x32_bf16 v[196:199], v[36:39], v[56:59], v[196:199]
  v_mfma_f32_16x16x32_bf16 v[156:159], v[32:35], v[60:63], v[156:159]
  v_mfma_f32_16x16x32_bf16 v[200:203], v[36:39], v[60:63], v[200:203]
  v_mfma_f32_16x16x32_bf16 v[160:163], v[32:35], v[64:67], v[160:163]
  v_mfma_f32_16x16x32_bf16 v[204:207], v[36:39], v[64:67], v[204:207]
  v_mfma_f32_16x16x32_bf16 v[164:167], v[32:35], v[68:71], v[164:167]
  v_mfma_f32_16x16x32_bf16 v[208:211], v[36:39], v[68:71], v[208:211]
  v_mfma_f32_16x16x32_bf16 v[168:171], v[32:35], v[72:75], v[168:171]
  v_mfma_f32_16x16x32_bf16 v[212:215], v[36:39], v[72:75], v[212:215]
  v_mfma_f32_16x16x32_bf16 v[172:175], v[32:35], v[76:79], v[172:175]
  v_mfma_f32_16x16x32_bf16 v[216:219], v[36:39], v[76:79], v[216:219]
  v_mfma_f32_16x16x32_bf16 v[176:179], v[32:35], v[80:83], v[176:179]
  v_mfma_f32_16x16x32_bf16 v[220:223], v[36:39], v[80:83], v[220:223]
  s_waitcnt lgkmcnt(0)
  s_barrier
  v_add_u32 v14, 40960, v14
  v_add_u32 v15, 40960, v15
  v_add_u32 v16, 40960, v16
  v_add_u32 v17, 40960, v17
  v_add_u32 v18, 40960, v18
  v_add_u32 v19, 40960, v19
  v_add_u32 v20, 40960, v20
  v_add_u32 v21, 40960, v21
  v_add_u32 v22, 40960, v22
  v_add_u32 v23, 40960, v23
  v_add_u32 v24, 40960, v24
  ds_read_b128 v[32:35], v14 offset:0
  ds_read_b128 v[36:39], v14 offset:2048
  ds_read_b128 v[40:43], v16 offset:0
  ds_read_b128 v[44:47], v16 offset:2048
  ds_read_b128 v[48:51], v16 offset:4096
  ds_read_b128 v[52:55], v16 offset:6144
  ds_read_b64_tr_b16 v[56:57], v18 offset:0
  ds_read_b64_tr_b16 v[58:59], v18 offset:1024
  ds_read_b64_tr_b16 v[60:61], v19 offset:0
  ds_read_b64_tr_b16 v[62:63], v19 offset:1024
  ds_read_b64_tr_b16 v[64:65], v20 offset:0
  ds_read_b64_tr_b16 v[66:67], v20 offset:1024
  ds_read_b64_tr_b16 v[68:69], v21 offset:0
  ds_read_b64_tr_b16 v[70:71], v21 offset:1024
  ds_read_b64_tr_b16 v[72:73], v22 offset:0
  ds_read_b64_tr_b16 v[74:75], v22 offset:1024
  ds_read_b64_tr_b16 v[76:77], v23 offset:0
  ds_read_b64_tr_b16 v[78:79], v23 offset:1024
  ds_read_b64_tr_b16 v[80:81], v24 offset:0
  ds_read_b64_tr_b16 v[82:83], v24 offset:1024
  v_mfma_f32_16x16x32_bf16 v[136:139], v[84:87], v[92:95], v[136:139]
  v_mfma_f32_16x16x32_bf16 v[180:183], v[88:91], v[92:95], v[180:183]
  v_mfma_f32_16x16x32_bf16 v[140:143], v[84:87], v[96:99], v[140:143]
  v_mfma_f32_16x16x32_bf16 v[184:187], v[88:91], v[96:99], v[184:187]
  v_mfma_f32_16x16x32_bf16 v[144:147], v[84:87], v[100:103], v[144:147]
  v_mfma_f32_16x16x32_bf16 v[188:191], v[88:91], v[100:103], v[188:191]
  v_mfma_f32_16x16x32_bf16 v[148:151], v[84:87], v[104:107], v[148:151]
  v_mfma_f32_16x16x32_bf16 v[192:195], v[88:91], v[104:107], v[192:195]
  v_mfma_f32_16x16x32_bf16 v[152:155], v[84:87], v[108:111], v[152:155]
  v_mfma_f32_16x16x32_bf16 v[196:199], v[88:91], v[108:111], v[196:199]
  v_mfma_f32_16x16x32_bf16 v[156:159], v[84:87], v[112:115], v[156:159]
  v_mfma_f32_16x16x32_bf16 v[200:203], v[88:91], v[112:115], v[200:203]
  v_mfma_f32_16x16x32_bf16 v[160:163], v[84:87], v[116:119], v[160:163]
  v_mfma_f32_16x16x32_bf16 v[204:207], v[88:91], v[116:119], v[204:207]
  v_mfma_f32_16x16x32_bf16 v[164:167], v[84:87], v[120:123], v[164:167]
  v_mfma_f32_16x16x32_bf16 v[208:211], v[88:91], v[120:123], v[208:211]
  v_mfma_f32_16x16x32_bf16 v[168:171], v[84:87], v[124:127], v[168:171]
  v_mfma_f32_16x16x32_bf16 v[212:215], v[88:91], v[124:127], v[212:215]
  v_mfma_f32_16x16x32_bf16 v[172:175], v[84:87], v[128:131], v[172:175]
  v_mfma_f32_16x16x32_bf16 v[216:219], v[88:91], v[128:131], v[216:219]
  v_mfma_f32_16x16x32_bf16 v[176:179], v[84:87], v[132:135], v[176:179]
  v_mfma_f32_16x16x32_bf16 v[220:223], v[88:91], v[132:135], v[220:223]
  s_waitcnt lgkmcnt(0)
  ds_read_b128 v[84:87], v15 offset:0
  ds_read_b128 v[88:91], v15 offset:2048
  ds_read_b128 v[92:95], v17 offset:0
  ds_read_b128 v[96:99], v17 offset:2048
  ds_read_b128 v[100:103], v17 offset:4096
  ds_read_b128 v[104:107], v17 offset:6144
  ds_read_b64_tr_b16 v[108:109], v18 offset:8192
  ds_read_b64_tr_b16 v[110:111], v18 offset:9216
  ds_read_b64_tr_b16 v[112:113], v19 offset:8192
  ds_read_b64_tr_b16 v[114:115], v19 offset:9216
  ds_read_b64_tr_b16 v[116:117], v20 offset:8192
  ds_read_b64_tr_b16 v[118:119], v20 offset:9216
  ds_read_b64_tr_b16 v[120:121], v21 offset:8192
  ds_read_b64_tr_b16 v[122:123], v21 offset:9216
  ds_read_b64_tr_b16 v[124:125], v22 offset:8192
  ds_read_b64_tr_b16 v[126:127], v22 offset:9216
  ds_read_b64_tr_b16 v[128:129], v23 offset:8192
  ds_read_b64_tr_b16 v[130:131], v23 offset:9216
  ds_read_b64_tr_b16 v[132:133], v24 offset:8192
  ds_read_b64_tr_b16 v[134:135], v24 offset:9216
  v_mfma_f32_16x16x32_bf16 v[136:139], v[32:35], v[40:43], v[136:139]
  v_mfma_f32_16x16x32_bf16 v[180:183], v[36:39], v[40:43], v[180:183]
  v_mfma_f32_16x16x32_bf16 v[140:143], v[32:35], v[44:47], v[140:143]
  v_mfma_f32_16x16x32_bf16 v[184:187], v[36:39], v[44:47], v[184:187]
  v_mfma_f32_16x16x32_bf16 v[144:147], v[32:35], v[48:51], v[144:147]
  v_mfma_f32_16x16x32_bf16 v[188:191], v[36:39], v[48:51], v[188:191]
  v_mfma_f32_16x16x32_bf16 v[148:151], v[32:35], v[52:55], v[148:151]
  v_mfma_f32_16x16x32_bf16 v[192:195], v[36:39], v[52:55], v[192:195]
  v_mfma_f32_16x16x32_bf16 v[152:155], v[32:35], v[56:59], v[152:155]
  v_mfma_f32_16x16x32_bf16 v[196:199], v[36:39], v[56:59], v[196:199]
  v_mfma_f32_16x16x32_bf16 v[156:159], v[32:35], v[60:63], v[156:159]
  v_mfma_f32_16x16x32_bf16 v[200:203], v[36:39], v[60:63], v[200:203]
  v_mfma_f32_16x16x32_bf16 v[160:163], v[32:35], v[64:67], v[160:163]
  v_mfma_f32_16x16x32_bf16 v[204:207], v[36:39], v[64:67], v[204:207]
  v_mfma_f32_16x16x32_bf16 v[164:167], v[32:35], v[68:71], v[164:167]
  v_mfma_f32_16x16x32_bf16 v[208:211], v[36:39], v[68:71], v[208:211]
  v_mfma_f32_16x16x32_bf16 v[168:171], v[32:35], v[72:75], v[168:171]
  v_mfma_f32_16x16x32_bf16 v[212:215], v[36:39], v[72:75], v[212:215]
  v_mfma_f32_16x16x32_bf16 v[172:175], v[32:35], v[76:79], v[172:175]
  v_mfma_f32_16x16x32_bf16 v[216:219], v[36:39], v[76:79], v[216:219]
  v_mfma_f32_16x16x32_bf16 v[176:179], v[32:35], v[80:83], v[176:179]
  v_mfma_f32_16x16x32_bf16 v[220:223], v[36:39], v[80:83], v[220:223]
  s_waitcnt lgkmcnt(0)
  s_barrier
  v_add_u32 v14, -81920, v14
  v_add_u32 v15, -81920, v15
  v_add_u32 v16, -81920, v16
  v_add_u32 v17, -81920, v17
  v_add_u32 v18, -81920, v18
  v_add_u32 v19, -81920, v19
  v_add_u32 v20, -81920, v20
  v_add_u32 v21, -81920, v21
  v_add_u32 v22, -81920, v22
  v_add_u32 v23, -81920, v23
  v_add_u32 v24, -81920, v24
  ds_read_b128 v[32:35], v14 offset:0
  ds_read_b128 v[36:39], v14 offset:2048
  ds_read_b128 v[40:43], v16 offset:0
  ds_read_b128 v[44:47], v16 offset:2048
  ds_read_b128 v[48:51], v16 offset:4096
  ds_read_b128 v[52:55], v16 offset:6144
  ds_read_b64_tr_b16 v[56:57], v18 offset:0
  ds_read_b64_tr_b16 v[58:59], v18 offset:1024
  ds_read_b64_tr_b16 v[60:61], v19 offset:0
  ds_read_b64_tr_b16 v[62:63], v19 offset:1024
  ds_read_b64_tr_b16 v[64:65], v20 offset:0
  ds_read_b64_tr_b16 v[66:67], v20 offset:1024
  ds_read_b64_tr_b16 v[68:69], v21 offset:0
  ds_read_b64_tr_b16 v[70:71], v21 offset:1024
  ds_read_b64_tr_b16 v[72:73], v22 offset:0
  ds_read_b64_tr_b16 v[74:75], v22 offset:1024
  ds_read_b64_tr_b16 v[76:77], v23 offset:0
  ds_read_b64_tr_b16 v[78:79], v23 offset:1024
  ds_read_b64_tr_b16 v[80:81], v24 offset:0
  ds_read_b64_tr_b16 v[82:83], v24 offset:1024
  v_mfma_f32_16x16x32_bf16 v[136:139], v[84:87], v[92:95], v[136:139]
  v_mfma_f32_16x16x32_bf16 v[180:183], v[88:91], v[92:95], v[180:183]
  v_mfma_f32_16x16x32_bf16 v[140:143], v[84:87], v[96:99], v[140:143]
  v_mfma_f32_16x16x32_bf16 v[184:187], v[88:91], v[96:99], v[184:187]
  v_mfma_f32_16x16x32_bf16 v[144:147], v[84:87], v[100:103], v[144:147]
  v_mfma_f32_16x16x32_bf16 v[188:191], v[88:91], v[100:103], v[188:191]
  v_mfma_f32_16x16x32_bf16 v[148:151], v[84:87], v[104:107], v[148:151]
  v_mfma_f32_16x16x32_bf16 v[192:195], v[88:91], v[104:107], v[192:195]
  v_mfma_f32_16x16x32_bf16 v[152:155], v[84:87], v[108:111], v[152:155]
  v_mfma_f32_16x16x32_bf16 v[196:199], v[88:91], v[108:111], v[196:199]
  v_mfma_f32_16x16x32_bf16 v[156:159], v[84:87], v[112:115], v[156:159]
  v_mfma_f32_16x16x32_bf16 v[200:203], v[88:91], v[112:115], v[200:203]
  v_mfma_f32_16x16x32_bf16 v[160:163], v[84:87], v[116:119], v[160:163]
  v_mfma_f32_16x16x32_bf16 v[204:207], v[88:91], v[116:119], v[204:207]
  v_mfma_f32_16x16x32_bf16 v[164:167], v[84:87], v[120:123], v[164:167]
  v_mfma_f32_16x16x32_bf16 v[208:211], v[88:91], v[120:123], v[208:211]
  v_mfma_f32_16x16x32_bf16 v[168:171], v[84:87], v[124:127], v[168:171]
  v_mfma_f32_16x16x32_bf16 v[212:215], v[88:91], v[124:127], v[212:215]
  v_mfma_f32_16x16x32_bf16 v[172:175], v[84:87], v[128:131], v[172:175]
  v_mfma_f32_16x16x32_bf16 v[216:219], v[88:91], v[128:131], v[216:219]
  v_mfma_f32_16x16x32_bf16 v[176:179], v[84:87], v[132:135], v[176:179]
  v_mfma_f32_16x16x32_bf16 v[220:223], v[88:91], v[132:135], v[220:223]
  s_waitcnt lgkmcnt(0)
  ds_read_b128 v[84:87], v15 offset:0
  ds_read_b128 v[88:91], v15 offset:2048
  ds_read_b128 v[92:95], v17 offset:0
  ds_read_b128 v[96:99], v17 offset:2048
  ds_read_b128 v[100:103], v17 offset:4096
  ds_read_b128 v[104:107], v17 offset:6144
  ds_read_b64_tr_b16 v[108:109], v18 offset:8192
  ds_read_b64_tr_b16 v[110:111], v18 offset:9216
  ds_read_b64_tr_b16 v[112:113], v19 offset:8192
  ds_read_b64_tr_b16 v[114:115], v19 offset:9216
  ds_read_b64_tr_b16 v[116:117], v20 offset:8192
  ds_read_b64_tr_b16 v[118:119], v20 offset:9216
  ds_read_b64_tr_b16 v[120:121], v21 offset:8192
  ds_read_b64_tr_b16 v[122:123], v21 offset:9216
  ds_read_b64_tr_b16 v[124:125], v22 offset:8192
  ds_read_b64_tr_b16 v[126:127], v22 offset:9216
  ds_read_b64_tr_b16 v[128:129], v23 offset:8192
  ds_read_b64_tr_b16 v[130:131], v23 offset:9216
  ds_read_b64_tr_b16 v[132:133], v24 offset:8192
  ds_read_b64_tr_b16 v[134:135], v24 offset:9216
  v_mfma_f32_16x16x32_bf16 v[136:139], v[32:35], v[40:43], v[136:139]
  v_mfma_f32_16x16x32_bf16 v[180:183], v[36:39], v[40:43], v[180:183]
  v_mfma_f32_16x16x32_bf16 v[140:143], v[32:35], v[44:47], v[140:143]
  v_mfma_f32_16x16x32_bf16 v[184:187], v[36:39], v[44:47], v[184:187]
  v_mfma_f32_16x16x32_bf16 v[144:147], v[32:35], v[48:51], v[144:147]
  v_mfma_f32_16x16x32_bf16 v[188:191], v[36:39], v[48:51], v[188:191]
  v_mfma_f32_16x16x32_bf16 v[148:151], v[32:35], v[52:55], v[148:151]
  v_mfma_f32_16x16x32_bf16 v[192:195], v[36:39], v[52:55], v[192:195]
  v_mfma_f32_16x16x32_bf16 v[152:155], v[32:35], v[56:59], v[152:155]
  v_mfma_f32_16x16x32_bf16 v[196:199], v[36:39], v[56:59], v[196:199]
  v_mfma_f32_16x16x32_bf16 v[156:159], v[32:35], v[60:63], v[156:159]
  v_mfma_f32_16x16x32_bf16 v[200:203], v[36:39], v[60:63], v[200:203]
  v_mfma_f32_16x16x32_bf16 v[160:163], v[32:35], v[64:67], v[160:163]
  v_mfma_f32_16x16x32_bf16 v[204:207], v[36:39], v[64:67], v[204:207]
  v_mfma_f32_16x16x32_bf16 v[164:167], v[32:35], v[68:71], v[164:167]
  v_mfma_f32_16x16x32_bf16 v[208:211], v[36:39], v[68:71], v[208:211]
  v_mfma_f32_16x16x32_bf16 v[168:171], v[32:35], v[72:75], v[168:171]
  v_mfma_f32_16x16x32_bf16 v[212:215], v[36:39], v[72:75], v[212:215]
  v_mfma_f32_16x16x32_bf16 v[172:175], v[32:35], v[76:79], v[172:175]
  v_mfma_f32_16x16x32_bf16 v[216:219], v[36:39], v[76:79], v[216:219]
  v_mfma_f32_16x16x32_bf16 v[176:179], v[32:35], v[80:83], v[176:179]
  v_mfma_f32_16x16x32_bf16 v[220:223], v[36:39], v[80:83], v[220:223]
  s_waitcnt lgkmcnt(0)
  s_barrier
  v_add_u32 v14, 40960, v14
  v_add_u32 v15, 40960, v15
  v_add_u32 v16, 40960, v16
  v_add_u32 v17, 40960, v17
  v_add_u32 v18, 40960, v18
  v_add_u32 v19, 40960, v19
  v_add_u32 v20, 40960, v20
  v_add_u32 v21, 40960, v21
  v_add_u32 v22, 40960, v22
  v_add_u32 v23, 40960, v23
  v_add_u32 v24, 40960, v24
  ds_read_b128 v[32:35], v14 offset:0
  ds_read_b128 v[36:39], v14 offset:2048
  ds_read_b128 v[40:43], v16 offset:0
  ds_read_b128 v[44:47], v16 offset:2048
  ds_read_b128 v[48:51], v16 offset:4096
  ds_read_b128 v[52:55], v16 offset:6144
  ds_read_b64_tr_b16 v[56:57], v18 offset:0
  ds_read_b64_tr_b16 v[58:59], v18 offset:1024
  ds_read_b64_tr_b16 v[60:61], v19 offset:0
  ds_read_b64_tr_b16 v[62:63], v19 offset:1024
  ds_read_b64_tr_b16 v[64:65], v20 offset:0
  ds_read_b64_tr_b16 v[66:67], v20 offset:1024
  ds_read_b64_tr_b16 v[68:69], v21 offset:0
  ds_read_b64_tr_b16 v[70:71], v21 offset:1024
  ds_read_b64_tr_b16 v[72:73], v22 offset:0
  ds_read_b64_tr_b16 v[74:75], v22 offset:1024
  ds_read_b64_tr_b16 v[76:77], v23 offset:0
  ds_read_b64_tr_b16 v[78:79], v23 offset:1024
  ds_read_b64_tr_b16 v[80:81], v24 offset:0
  ds_read_b64_tr_b16 v[82:83], v24 offset:1024
  v_mfma_f32_16x16x32_bf16 v[136:139], v[84:87], v[92:95], v[136:139]
  v_mfma_f32_16x16x32_bf16 v[180:183], v[88:91], v[92:95], v[180:183]
  v_mfma_f32_16x16x32_bf16 v[140:143], v[84:87], v[96:99], v[140:143]
  v_mfma_f32_16x16x32_bf16 v[184:187], v[88:91], v[96:99], v[184:187]
  v_mfma_f32_16x16x32_bf16 v[144:147], v[84:87], v[100:103], v[144:147]
  v_mfma_f32_16x16x32_bf16 v[188:191], v[88:91], v[100:103], v[188:191]
  v_mfma_f32_16x16x32_bf16 v[148:151], v[84:87], v[104:107], v[148:151]
  v_mfma_f32_16x16x32_bf16 v[192:195], v[88:91], v[104:107], v[192:195]
  v_mfma_f32_16x16x32_bf16 v[152:155], v[84:87], v[108:111], v[152:155]
  v_mfma_f32_16x16x32_bf16 v[196:199], v[88:91], v[108:111], v[196:199]
  v_mfma_f32_16x16x32_bf16 v[156:159], v[84:87], v[112:115], v[156:159]
  v_mfma_f32_16x16x32_bf16 v[200:203], v[88:91], v[112:115], v[200:203]
  v_mfma_f32_16x16x32_bf16 v[160:163], v[84:87], v[116:119], v[160:163]
  v_mfma_f32_16x16x32_bf16 v[204:207], v[88:91], v[116:119], v[204:207]
  v_mfma_f32_16x16x32_bf16 v[164:167], v[84:87], v[120:123], v[164:167]
  v_mfma_f32_16x16x32_bf16 v[208:211], v[88:91], v[120:123], v[208:211]
  v_mfma_f32_16x16x32_bf16 v[168:171], v[84:87], v[124:127], v[168:171]
  v_mfma_f32_16x16x32_bf16 v[212:215], v[88:91], v[124:127], v[212:215]
  v_mfma_f32_16x16x32_bf16 v[172:175], v[84:87], v[128:131], v[172:175]
  v_mfma_f32_16x16x32_bf16 v[216:219], v[88:91], v[128:131], v[216:219]
  v_mfma_f32_16x16x32_bf16 v[176:179], v[84:87], v[132:135], v[176:179]
  v_mfma_f32_16x16x32_bf16 v[220:223], v[88:91], v[132:135], v[220:223]
  s_waitcnt lgkmcnt(0)
  ds_read_b128 v[84:87], v15 offset:0
  ds_read_b128 v[88:91], v15 offset:2048
  ds_read_b128 v[92:95], v17 offset:0
  ds_read_b128 v[96:99], v17 offset:2048
  ds_read_b128 v[100:103], v17 offset:4096
  ds_read_b128 v[104:107], v17 offset:6144
  ds_read_b64_tr_b16 v[108:109], v18 offset:8192
  ds_read_b64_tr_b16 v[110:111], v18 offset:9216
  ds_read_b64_tr_b16 v[112:113], v19 offset:8192
  ds_read_b64_tr_b16 v[114:115], v19 offset:9216
  ds_read_b64_tr_b16 v[116:117], v20 offset:8192
  ds_read_b64_tr_b16 v[118:119], v20 offset:9216
  ds_read_b64_tr_b16 v[120:121], v21 offset:8192
  ds_read_b64_tr_b16 v[122:123], v21 offset:9216
  ds_read_b64_tr_b16 v[124:125], v22 offset:8192
  ds_read_b64_tr_b16 v[126:127], v22 offset:9216
  ds_read_b64_tr_b16 v[128:129], v23 offset:8192
  ds_read_b64_tr_b16 v[130:131], v23 offset:9216
  ds_read_b64_tr_b16 v[132:133], v24 offset:8192
  ds_read_b64_tr_b16 v[134:135], v24 offset:9216
  v_mfma_f32_16x16x32_bf16 v[136:139], v[32:35], v[40:43], v[136:139]
  v_mfma_f32_16x16x32_bf16 v[180:183], v[36:39], v[40:43], v[180:183]
  v_mfma_f32_16x16x32_bf16 v[140:143], v[32:35], v[44:47], v[140:143]
  v_mfma_f32_16x16x32_bf16 v[184:187], v[36:39], v[44:47], v[184:187]
  v_mfma_f32_16x16x32_bf16 v[144:147], v[32:35], v[48:51], v[144:147]
  v_mfma_f32_16x16x32_bf16 v[188:191], v[36:39], v[48:51], v[188:191]
  v_mfma_f32_16x16x32_bf16 v[148:151], v[32:35], v[52:55], v[148:151]
  v_mfma_f32_16x16x32_bf16 v[192:195], v[36:39], v[52:55], v[192:195]
  v_mfma_f32_16x16x32_bf16 v[152:155], v[32:35], v[56:59], v[152:155]
  v_mfma_f32_16x16x32_bf16 v[196:199], v[36:39], v[56:59], v[196:199]
  v_mfma_f32_16x16x32_bf16 v[156:159], v[32:35], v[60:63], v[156:159]
  v_mfma_f32_16x16x32_bf16 v[200:203], v[36:39], v[60:63], v[200:203]
  v_mfma_f32_16x16x32_bf16 v[160:163], v[32:35], v[64:67], v[160:163]
  v_mfma_f32_16x16x32_bf16 v[204:207], v[36:39], v[64:67], v[204:207]
  v_mfma_f32_16x16x32_bf16 v[164:167], v[32:35], v[68:71], v[164:167]
  v_mfma_f32_16x16x32_bf16 v[208:211], v[36:39], v[68:71], v[208:211]
  v_mfma_f32_16x16x32_bf16 v[168:171], v[32:35], v[72:75], v[168:171]
  v_mfma_f32_16x16x32_bf16 v[212:215], v[36:39], v[72:75], v[212:215]
  v_mfma_f32_16x16x32_bf16 v[172:175], v[32:35], v[76:79], v[172:175]
  v_mfma_f32_16x16x32_bf16 v[216:219], v[36:39], v[76:79], v[216:219]
  v_mfma_f32_16x16x32_bf16 v[176:179], v[32:35], v[80:83], v[176:179]
  v_mfma_f32_16x16x32_bf16 v[220:223], v[36:39], v[80:83], v[220:223]
  s_waitcnt lgkmcnt(0)
  s_barrier
  v_add_u32 v14, 40960, v14
  v_add_u32 v15, 40960, v15
  v_add_u32 v16, 40960, v16
  v_add_u32 v17, 40960, v17
  v_add_u32 v18, 40960, v18
  v_add_u32 v19, 40960, v19
  v_add_u32 v20, 40960, v20
  v_add_u32 v21, 40960, v21
  v_add_u32 v22, 40960, v22
  v_add_u32 v23, 40960, v23
  v_add_u32 v24, 40960, v24
  ds_read_b128 v[32:35], v14 offset:0
  ds_read_b128 v[36:39], v14 offset:2048
  ds_read_b128 v[40:43], v16 offset:0
  ds_read_b128 v[44:47], v16 offset:2048
  ds_read_b128 v[48:51], v16 offset:4096
  ds_read_b128 v[52:55], v16 offset:6144
  ds_read_b64_tr_b16 v[56:57], v18 offset:0
  ds_read_b64_tr_b16 v[58:59], v18 offset:1024
  ds_read_b64_tr_b16 v[60:61], v19 offset:0
  ds_read_b64_tr_b16 v[62:63], v19 offset:1024
  ds_read_b64_tr_b16 v[64:65], v20 offset:0
  ds_read_b64_tr_b16 v[66:67], v20 offset:1024
  ds_read_b64_tr_b16 v[68:69], v21 offset:0
  ds_read_b64_tr_b16 v[70:71], v21 offset:1024
  ds_read_b64_tr_b16 v[72:73], v22 offset:0
  ds_read_b64_tr_b16 v[74:75], v22 offset:1024
  ds_read_b64_tr_b16 v[76:77], v23 offset:0
  ds_read_b64_tr_b16 v[78:79], v23 offset:1024
  ds_read_b64_tr_b16 v[80:81], v24 offset:0
  ds_read_b64_tr_b16 v[82:83], v24 offset:1024
  v_mfma_f32_16x16x32_bf16 v[136:139], v[84:87], v[92:95], v[136:139]
  v_mfma_f32_16x16x32_bf16 v[180:183], v[88:91], v[92:95], v[180:183]
  v_mfma_f32_16x16x32_bf16 v[140:143], v[84:87], v[96:99], v[140:143]
  v_mfma_f32_16x16x32_bf16 v[184:187], v[88:91], v[96:99], v[184:187]
  v_mfma_f32_16x16x32_bf16 v[144:147], v[84:87], v[100:103], v[144:147]
  v_mfma_f32_16x16x32_bf16 v[188:191], v[88:91], v[100:103], v[188:191]
  v_mfma_f32_16x16x32_bf16 v[148:151], v[84:87], v[104:107], v[148:151]
  v_mfma_f32_16x16x32_bf16 v[192:195], v[88:91], v[104:107], v[192:195]
  v_mfma_f32_16x16x32_bf16 v[152:155], v[84:87], v[108:111], v[152:155]
  v_mfma_f32_16x16x32_bf16 v[196:199], v[88:91], v[108:111], v[196:199]
  v_mfma_f32_16x16x32_bf16 v[156:159], v[84:87], v[112:115], v[156:159]
  v_mfma_f32_16x16x32_bf16 v[200:203], v[88:91], v[112:115], v[200:203]
  v_mfma_f32_16x16x32_bf16 v[160:163], v[84:87], v[116:119], v[160:163]
  v_mfma_f32_16x16x32_bf16 v[204:207], v[88:91], v[116:119], v[204:207]
  v_mfma_f32_16x16x32_bf16 v[164:167], v[84:87], v[120:123], v[164:167]
  v_mfma_f32_16x16x32_bf16 v[208:211], v[88:91], v[120:123], v[208:211]
  v_mfma_f32_16x16x32_bf16 v[168:171], v[84:87], v[124:127], v[168:171]
  v_mfma_f32_16x16x32_bf16 v[212:215], v[88:91], v[124:127], v[212:215]
  v_mfma_f32_16x16x32_bf16 v[172:175], v[84:87], v[128:131], v[172:175]
  v_mfma_f32_16x16x32_bf16 v[216:219], v[88:91], v[128:131], v[216:219]
  v_mfma_f32_16x16x32_bf16 v[176:179], v[84:87], v[132:135], v[176:179]
  v_mfma_f32_16x16x32_bf16 v[220:223], v[88:91], v[132:135], v[220:223]
  s_waitcnt lgkmcnt(0)
  ds_read_b128 v[84:87], v15 offset:0
  ds_read_b128 v[88:91], v15 offset:2048
  ds_read_b128 v[92:95], v17 offset:0
  ds_read_b128 v[96:99], v17 offset:2048
  ds_read_b128 v[100:103], v17 offset:4096
  ds_read_b128 v[104:107], v17 offset:6144
  ds_read_b64_tr_b16 v[108:109], v18 offset:8192
  ds_read_b64_tr_b16 v[110:111], v18 offset:9216
  ds_read_b64_tr_b16 v[112:113], v19 offset:8192
  ds_read_b64_tr_b16 v[114:115], v19 offset:9216
  ds_read_b64_tr_b16 v[116:117], v20 offset:8192
  ds_read_b64_tr_b16 v[118:119], v20 offset:9216
  ds_read_b64_tr_b16 v[120:121], v21 offset:8192
  ds_read_b64_tr_b16 v[122:123], v21 offset:9216
  ds_read_b64_tr_b16 v[124:125], v22 offset:8192
  ds_read_b64_tr_b16 v[126:127], v22 offset:9216
  ds_read_b64_tr_b16 v[128:129], v23 offset:8192
  ds_read_b64_tr_b16 v[130:131], v23 offset:9216
  ds_read_b64_tr_b16 v[132:133], v24 offset:8192
  ds_read_b64_tr_b16 v[134:135], v24 offset:9216
  v_mfma_f32_16x16x32_bf16 v[136:139], v[32:35], v[40:43], v[136:139]
  v_mfma_f32_16x16x32_bf16 v[180:183], v[36:39], v[40:43], v[180:183]
  v_mfma_f32_16x16x32_bf16 v[140:143], v[32:35], v[44:47], v[140:143]
  v_mfma_f32_16x16x32_bf16 v[184:187], v[36:39], v[44:47], v[184:187]
  v_mfma_f32_16x16x32_bf16 v[144:147], v[32:35], v[48:51], v[144:147]
  v_mfma_f32_16x16x32_bf16 v[188:191], v[36:39], v[48:51], v[188:191]
  v_mfma_f32_16x16x32_bf16 v[148:151], v[32:35], v[52:55], v[148:151]
  v_mfma_f32_16x16x32_bf16 v[192:195], v[36:39], v[52:55], v[192:195]
  v_mfma_f32_16x16x32_bf16 v[152:155], v[32:35], v[56:59], v[152:155]
  v_mfma_f32_16x16x32_bf16 v[196:199], v[36:39], v[56:59], v[196:199]
  v_mfma_f32_16x16x32_bf16 v[156:159], v[32:35], v[60:63], v[156:159]
  v_mfma_f32_16x16x32_bf16 v[200:203], v[36:39], v[60:63], v[200:203]
  v_mfma_f32_16x16x32_bf16 v[160:163], v[32:35], v[64:67], v[160:163]
  v_mfma_f32_16x16x32_bf16 v[204:207], v[36:39], v[64:67], v[204:207]
  v_mfma_f32_16x16x32_bf16 v[164:167], v[32:35], v[68:71], v[164:167]
  v_mfma_f32_16x16x32_bf16 v[208:211], v[36:39], v[68:71], v[208:211]
  v_mfma_f32_16x16x32_bf16 v[168:171], v[32:35], v[72:75], v[168:171]
  v_mfma_f32_16x16x32_bf16 v[212:215], v[36:39], v[72:75], v[212:215]
  v_mfma_f32_16x16x32_bf16 v[172:175], v[32:35], v[76:79], v[172:175]
  v_mfma_f32_16x16x32_bf16 v[216:219], v[36:39], v[76:79], v[216:219]
  v_mfma_f32_16x16x32_bf16 v[176:179], v[32:35], v[80:83], v[176:179]
  v_mfma_f32_16x16x32_bf16 v[220:223], v[36:39], v[80:83], v[220:223]
  s_waitcnt lgkmcnt(0)
  s_barrier
  v_add_u32 v14, -81920, v14
  v_add_u32 v15, -81920, v15
  v_add_u32 v16, -81920, v16
  v_add_u32 v17, -81920, v17
  v_add_u32 v18, -81920, v18
  v_add_u32 v19, -81920, v19
  v_add_u32 v20, -81920, v20
  v_add_u32 v21, -81920, v21
  v_add_u32 v22, -81920, v22
  v_add_u32 v23, -81920, v23
  v_add_u32 v24, -81920, v24
  ds_read_b128 v[32:35], v14 offset:0
  ds_read_b128 v[36:39], v14 offset:2048
  ds_read_b128 v[40:43], v16 offset:0
  ds_read_b128 v[44:47], v16 offset:2048
  ds_read_b128 v[48:51], v16 offset:4096
  ds_read_b128 v[52:55], v16 offset:6144
  ds_read_b64_tr_b16 v[56:57], v18 offset:0
  ds_read_b64_tr_b16 v[58:59], v18 offset:1024
  ds_read_b64_tr_b16 v[60:61], v19 offset:0
  ds_read_b64_tr_b16 v[62:63], v19 offset:1024
  ds_read_b64_tr_b16 v[64:65], v20 offset:0
  ds_read_b64_tr_b16 v[66:67], v20 offset:1024
  ds_read_b64_tr_b16 v[68:69], v21 offset:0
  ds_read_b64_tr_b16 v[70:71], v21 offset:1024
  ds_read_b64_tr_b16 v[72:73], v22 offset:0
  ds_read_b64_tr_b16 v[74:75], v22 offset:1024
  ds_read_b64_tr_b16 v[76:77], v23 offset:0
  ds_read_b64_tr_b16 v[78:79], v23 offset:1024
  ds_read_b64_tr_b16 v[80:81], v24 offset:0
  ds_read_b64_tr_b16 v[82:83], v24 offset:1024
  v_mfma_f32_16x16x32_bf16 v[136:139], v[84:87], v[92:95], v[136:139]
  v_mfma_f32_16x16x32_bf16 v[180:183], v[88:91], v[92:95], v[180:183]
  v_mfma_f32_16x16x32_bf16 v[140:143], v[84:87], v[96:99], v[140:143]
  v_mfma_f32_16x16x32_bf16 v[184:187], v[88:91], v[96:99], v[184:187]
  v_mfma_f32_16x16x32_bf16 v[144:147], v[84:87], v[100:103], v[144:147]
  v_mfma_f32_16x16x32_bf16 v[188:191], v[88:91], v[100:103], v[188:191]
  v_mfma_f32_16x16x32_bf16 v[148:151], v[84:87], v[104:107], v[148:151]
  v_mfma_f32_16x16x32_bf16 v[192:195], v[88:91], v[104:107], v[192:195]
  v_mfma_f32_16x16x32_bf16 v[152:155], v[84:87], v[108:111], v[152:155]
  v_mfma_f32_16x16x32_bf16 v[196:199], v[88:91], v[108:111], v[196:199]
  v_mfma_f32_16x16x32_bf16 v[156:159], v[84:87], v[112:115], v[156:159]
  v_mfma_f32_16x16x32_bf16 v[200:203], v[88:91], v[112:115], v[200:203]
  v_mfma_f32_16x16x32_bf16 v[160:163], v[84:87], v[116:119], v[160:163]
  v_mfma_f32_16x16x32_bf16 v[204:207], v[88:91], v[116:119], v[204:207]
  v_mfma_f32_16x16x32_bf16 v[164:167], v[84:87], v[120:123], v[164:167]
  v_mfma_f32_16x16x32_bf16 v[208:211], v[88:91], v[120:123], v[208:211]
  v_mfma_f32_16x16x32_bf16 v[168:171], v[84:87], v[124:127], v[168:171]
  v_mfma_f32_16x16x32_bf16 v[212:215], v[88:91], v[124:127], v[212:215]
  v_mfma_f32_16x16x32_bf16 v[172:175], v[84:87], v[128:131], v[172:175]
  v_mfma_f32_16x16x32_bf16 v[216:219], v[88:91], v[128:131], v[216:219]
  v_mfma_f32_16x16x32_bf16 v[176:179], v[84:87], v[132:135], v[176:179]
  v_mfma_f32_16x16x32_bf16 v[220:223], v[88:91], v[132:135], v[220:223]
  s_waitcnt lgkmcnt(0)
  ds_read_b128 v[84:87], v15 offset:0
  ds_read_b128 v[88:91], v15 offset:2048
  ds_read_b128 v[92:95], v17 offset:0
  ds_read_b128 v[96:99], v17 offset:2048
  ds_read_b128 v[100:103], v17 offset:4096
  ds_read_b128 v[104:107], v17 offset:6144
  ds_read_b64_tr_b16 v[108:109], v18 offset:8192
  ds_read_b64_tr_b16 v[110:111], v18 offset:9216
  ds_read_b64_tr_b16 v[112:113], v19 offset:8192
  ds_read_b64_tr_b16 v[114:115], v19 offset:9216
  ds_read_b64_tr_b16 v[116:117], v20 offset:8192
  ds_read_b64_tr_b16 v[118:119], v20 offset:9216
  ds_read_b64_tr_b16 v[120:121], v21 offset:8192
  ds_read_b64_tr_b16 v[122:123], v21 offset:9216
  ds_read_b64_tr_b16 v[124:125], v22 offset:8192
  ds_read_b64_tr_b16 v[126:127], v22 offset:9216
  ds_read_b64_tr_b16 v[128:129], v23 offset:8192
  ds_read_b64_tr_b16 v[130:131], v23 offset:9216
  ds_read_b64_tr_b16 v[132:133], v24 offset:8192
  ds_read_b64_tr_b16 v[134:135], v24 offset:9216
  v_mfma_f32_16x16x32_bf16 v[136:139], v[32:35], v[40:43], v[136:139]
  v_mfma_f32_16x16x32_bf16 v[180:183], v[36:39], v[40:43], v[180:183]
  v_mfma_f32_16x16x32_bf16 v[140:143], v[32:35], v[44:47], v[140:143]
  v_mfma_f32_16x16x32_bf16 v[184:187], v[36:39], v[44:47], v[184:187]
  v_mfma_f32_16x16x32_bf16 v[144:147], v[32:35], v[48:51], v[144:147]
  v_mfma_f32_16x16x32_bf16 v[188:191], v[36:39], v[48:51], v[188:191]
  v_mfma_f32_16x16x32_bf16 v[148:151], v[32:35], v[52:55], v[148:151]
  v_mfma_f32_16x16x32_bf16 v[192:195], v[36:39], v[52:55], v[192:195]
  v_mfma_f32_16x16x32_bf16 v[152:155], v[32:35], v[56:59], v[152:155]
  v_mfma_f32_16x16x32_bf16 v[196:199], v[36:39], v[56:59], v[196:199]
  v_mfma_f32_16x16x32_bf16 v[156:159], v[32:35], v[60:63], v[156:159]
  v_mfma_f32_16x16x32_bf16 v[200:203], v[36:39], v[60:63], v[200:203]
  v_mfma_f32_16x16x32_bf16 v[160:163], v[32:35], v[64:67], v[160:163]
  v_mfma_f32_16x16x32_bf16 v[204:207], v[36:39], v[64:67], v[204:207]
  v_mfma_f32_16x16x32_bf16 v[164:167], v[32:35], v[68:71], v[164:167]
  v_mfma_f32_16x16x32_bf16 v[208:211], v[36:39], v[68:71], v[208:211]
  v_mfma_f32_16x16x32_bf16 v[168:171], v[32:35], v[72:75], v[168:171]
  v_mfma_f32_16x16x32_bf16 v[212:215], v[36:39], v[72:75], v[212:215]
  v_mfma_f32_16x16x32_bf16 v[172:175], v[32:35], v[76:79], v[172:175]
  v_mfma_f32_16x16x32_bf16 v[216:219], v[36:39], v[76:79], v[216:219]
  v_mfma_f32_16x16x32_bf16 v[176:179], v[32:35], v[80:83], v[176:179]
  v_mfma_f32_16x16x32_bf16 v[220:223], v[36:39], v[80:83], v[220:223]
  s_waitcnt lgkmcnt(0)
  s_barrier
  v_add_u32 v14, 40960, v14
  v_add_u32 v15, 40960, v15
  v_add_u32 v16, 40960, v16
  v_add_u32 v17, 40960, v17
  v_add_u32 v18, 40960, v18
  v_add_u32 v19, 40960, v19
  v_add_u32 v20, 40960, v20
  v_add_u32 v21, 40960, v21
  v_add_u32 v22, 40960, v22
  v_add_u32 v23, 40960, v23
  v_add_u32 v24, 40960, v24
  ds_read_b128 v[32:35], v14 offset:0
  ds_read_b128 v[36:39], v14 offset:2048
  ds_read_b128 v[40:43], v16 offset:0
  ds_read_b128 v[44:47], v16 offset:2048
  ds_read_b128 v[48:51], v16 offset:4096
  ds_read_b128 v[52:55], v16 offset:6144
  ds_read_b64_tr_b16 v[56:57], v18 offset:0
  ds_read_b64_tr_b16 v[58:59], v18 offset:1024
  ds_read_b64_tr_b16 v[60:61], v19 offset:0
  ds_read_b64_tr_b16 v[62:63], v19 offset:1024
  ds_read_b64_tr_b16 v[64:65], v20 offset:0
  ds_read_b64_tr_b16 v[66:67], v20 offset:1024
  ds_read_b64_tr_b16 v[68:69], v21 offset:0
  ds_read_b64_tr_b16 v[70:71], v21 offset:1024
  ds_read_b64_tr_b16 v[72:73], v22 offset:0
  ds_read_b64_tr_b16 v[74:75], v22 offset:1024
  ds_read_b64_tr_b16 v[76:77], v23 offset:0
  ds_read_b64_tr_b16 v[78:79], v23 offset:1024
  ds_read_b64_tr_b16 v[80:81], v24 offset:0
  ds_read_b64_tr_b16 v[82:83], v24 offset:1024
  v_mfma_f32_16x16x32_bf16 v[136:139], v[84:87], v[92:95], v[136:139]
  v_mfma_f32_16x16x32_bf16 v[180:183], v[88:91], v[92:95], v[180:183]
  v_mfma_f32_16x16x32_bf16 v[140:143], v[84:87], v[96:99], v[140:143]
  v_mfma_f32_16x16x32_bf16 v[184:187], v[88:91], v[96:99], v[184:187]
  v_mfma_f32_16x16x32_bf16 v[144:147], v[84:87], v[100:103], v[144:147]
  v_mfma_f32_16x16x32_bf16 v[188:191], v[88:91], v[100:103], v[188:191]
  v_mfma_f32_16x16x32_bf16 v[148:151], v[84:87], v[104:107], v[148:151]
  v_mfma_f32_16x16x32_bf16 v[192:195], v[88:91], v[104:107], v[192:195]
  v_mfma_f32_16x16x32_bf16 v[152:155], v[84:87], v[108:111], v[152:155]
  v_mfma_f32_16x16x32_bf16 v[196:199], v[88:91], v[108:111], v[196:199]
  v_mfma_f32_16x16x32_bf16 v[156:159], v[84:87], v[112:115], v[156:159]
  v_mfma_f32_16x16x32_bf16 v[200:203], v[88:91], v[112:115], v[200:203]
  v_mfma_f32_16x16x32_bf16 v[160:163], v[84:87], v[116:119], v[160:163]
  v_mfma_f32_16x16x32_bf16 v[204:207], v[88:91], v[116:119], v[204:207]
  v_mfma_f32_16x16x32_bf16 v[164:167], v[84:87], v[120:123], v[164:167]
  v_mfma_f32_16x16x32_bf16 v[208:211], v[88:91], v[120:123], v[208:211]
  v_mfma_f32_16x16x32_bf16 v[168:171], v[84:87], v[124:127], v[168:171]
  v_mfma_f32_16x16x32_bf16 v[212:215], v[88:91], v[124:127], v[212:215]
  v_mfma_f32_16x16x32_bf16 v[172:175], v[84:87], v[128:131], v[172:175]
  v_mfma_f32_16x16x32_bf16 v[216:219], v[88:91], v[128:131], v[216:219]
  v_mfma_f32_16x16x32_bf16 v[176:179], v[84:87], v[132:135], v[176:179]
  v_mfma_f32_16x16x32_bf16 v[220:223], v[88:91], v[132:135], v[220:223]
  s_waitcnt lgkmcnt(0)
  ds_read_b128 v[84:87], v15 offset:0
  ds_read_b128 v[88:91], v15 offset:2048
  ds_read_b128 v[92:95], v17 offset:0
  ds_read_b128 v[96:99], v17 offset:2048
  ds_read_b128 v[100:103], v17 offset:4096
  ds_read_b128 v[104:107], v17 offset:6144
  ds_read_b64_tr_b16 v[108:109], v18 offset:8192
  ds_read_b64_tr_b16 v[110:111], v18 offset:9216
  ds_read_b64_tr_b16 v[112:113], v19 offset:8192
  ds_read_b64_tr_b16 v[114:115], v19 offset:9216
  ds_read_b64_tr_b16 v[116:117], v20 offset:8192
  ds_read_b64_tr_b16 v[118:119], v20 offset:9216
  ds_read_b64_tr_b16 v[120:121], v21 offset:8192
  ds_read_b64_tr_b16 v[122:123], v21 offset:9216
  ds_read_b64_tr_b16 v[124:125], v22 offset:8192
  ds_read_b64_tr_b16 v[126:127], v22 offset:9216
  ds_read_b64_tr_b16 v[128:129], v23 offset:8192
  ds_read_b64_tr_b16 v[130:131], v23 offset:9216
  ds_read_b64_tr_b16 v[132:133], v24 offset:8192
  ds_read_b64_tr_b16 v[134:135], v24 offset:9216
  v_mfma_f32_16x16x32_bf16 v[136:139], v[32:35], v[40:43], v[136:139]
  v_mfma_f32_16x16x32_bf16 v[180:183], v[36:39], v[40:43], v[180:183]
  v_mfma_f32_16x16x32_bf16 v[140:143], v[32:35], v[44:47], v[140:143]
  v_mfma_f32_16x16x32_bf16 v[184:187], v[36:39], v[44:47], v[184:187]
  v_mfma_f32_16x16x32_bf16 v[144:147], v[32:35], v[48:51], v[144:147]
  v_mfma_f32_16x16x32_bf16 v[188:191], v[36:39], v[48:51], v[188:191]
  v_mfma_f32_16x16x32_bf16 v[148:151], v[32:35], v[52:55], v[148:151]
  v_mfma_f32_16x16x32_bf16 v[192:195], v[36:39], v[52:55], v[192:195]
  v_mfma_f32_16x16x32_bf16 v[152:155], v[32:35], v[56:59], v[152:155]
  v_mfma_f32_16x16x32_bf16 v[196:199], v[36:39], v[56:59], v[196:199]
  v_mfma_f32_16x16x32_bf16 v[156:159], v[32:35], v[60:63], v[156:159]
  v_mfma_f32_16x16x32_bf16 v[200:203], v[36:39], v[60:63], v[200:203]
  v_mfma_f32_16x16x32_bf16 v[160:163], v[32:35], v[64:67], v[160:163]
  v_mfma_f32_16x16x32_bf16 v[204:207], v[36:39], v[64:67], v[204:207]
  v_mfma_f32_16x16x32_bf16 v[164:167], v[32:35], v[68:71], v[164:167]
  v_mfma_f32_16x16x32_bf16 v[208:211], v[36:39], v[68:71], v[208:211]
  v_mfma_f32_16x16x32_bf16 v[168:171], v[32:35], v[72:75], v[168:171]
  v_mfma_f32_16x16x32_bf16 v[212:215], v[36:39], v[72:75], v[212:215]
  v_mfma_f32_16x16x32_bf16 v[172:175], v[32:35], v[76:79], v[172:175]
  v_mfma_f32_16x16x32_bf16 v[216:219], v[36:39], v[76:79], v[216:219]
  v_mfma_f32_16x16x32_bf16 v[176:179], v[32:35], v[80:83], v[176:179]
  v_mfma_f32_16x16x32_bf16 v[220:223], v[36:39], v[80:83], v[220:223]
  s_waitcnt lgkmcnt(0)
  v_mfma_f32_16x16x32_bf16 v[136:139], v[84:87], v[92:95], v[136:139]
  v_mfma_f32_16x16x32_bf16 v[180:183], v[88:91], v[92:95], v[180:183]
  v_mfma_f32_16x16x32_bf16 v[140:143], v[84:87], v[96:99], v[140:143]
  v_mfma_f32_16x16x32_bf16 v[184:187], v[88:91], v[96:99], v[184:187]
  v_mfma_f32_16x16x32_bf16 v[144:147], v[84:87], v[100:103], v[144:147]
  v_mfma_f32_16x16x32_bf16 v[188:191], v[88:91], v[100:103], v[188:191]
  v_mfma_f32_16x16x32_bf16 v[148:151], v[84:87], v[104:107], v[148:151]
  v_mfma_f32_16x16x32_bf16 v[192:195], v[88:91], v[104:107], v[192:195]
  v_mfma_f32_16x16x32_bf16 v[152:155], v[84:87], v[108:111], v[152:155]
  v_mfma_f32_16x16x32_bf16 v[196:199], v[88:91], v[108:111], v[196:199]
  v_mfma_f32_16x16x32_bf16 v[156:159], v[84:87], v[112:115], v[156:159]
  v_mfma_f32_16x16x32_bf16 v[200:203], v[88:91], v[112:115], v[200:203]
  v_mfma_f32_16x16x32_bf16 v[160:163], v[84:87], v[116:119], v[160:163]
  v_mfma_f32_16x16x32_bf16 v[204:207], v[88:91], v[116:119], v[204:207]
  v_mfma_f32_16x16x32_bf16 v[164:167], v[84:87], v[120:123], v[164:167]
  v_mfma_f32_16x16x32_bf16 v[208:211], v[88:91], v[120:123], v[208:211]
  v_mfma_f32_16x16x32_bf16 v[168:171], v[84:87], v[124:127], v[168:171]
  v_mfma_f32_16x16x32_bf16 v[212:215], v[88:91], v[124:127], v[212:215]
  v_mfma_f32_16x16x32_bf16 v[172:175], v[84:87], v[128:131], v[172:175]
  v_mfma_f32_16x16x32_bf16 v[216:219], v[88:91], v[128:131], v[216:219]
  v_mfma_f32_16x16x32_bf16 v[176:179], v[84:87], v[132:135], v[176:179]
  v_mfma_f32_16x16x32_bf16 v[220:223], v[88:91], v[132:135], v[220:223]
  s_nop 7
  s_nop 7
  s_barrier
  v_lshlrev_b32 v5, 2, v4
  s_lshl_b32 s47, s34, 5
  v_add_u32 v5, s47, v5
  s_movk_i32 s48, 272
  v_mul_lo_u32 v5, v5, s48
  v_and_b32 v6, 15, v1
  v_lshl_add_u32 v26, v6, 2, v5
  ds_write_b32 v26, v136 offset:0
  ds_write_b32 v26, v137 offset:272
  ds_write_b32 v26, v138 offset:544
  ds_write_b32 v26, v139 offset:816
  ds_write_b32 v26, v140 offset:64
  ds_write_b32 v26, v141 offset:336
  ds_write_b32 v26, v142 offset:608
  ds_write_b32 v26, v143 offset:880
  ds_write_b32 v26, v144 offset:128
  ds_write_b32 v26, v145 offset:400
  ds_write_b32 v26, v146 offset:672
  ds_write_b32 v26, v147 offset:944
  ds_write_b32 v26, v148 offset:192
  ds_write_b32 v26, v149 offset:464
  ds_write_b32 v26, v150 offset:736
  ds_write_b32 v26, v151 offset:1008
  ds_write_b32 v26, v180 offset:4352
  ds_write_b32 v26, v181 offset:4624
  ds_write_b32 v26, v182 offset:4896
  ds_write_b32 v26, v183 offset:5168
  ds_write_b32 v26, v184 offset:4416
  ds_write_b32 v26, v185 offset:4688
  ds_write_b32 v26, v186 offset:4960
  ds_write_b32 v26, v187 offset:5232
  ds_write_b32 v26, v188 offset:4480
  ds_write_b32 v26, v189 offset:4752
  ds_write_b32 v26, v190 offset:5024
  ds_write_b32 v26, v191 offset:5296
  ds_write_b32 v26, v192 offset:4544
  ds_write_b32 v26, v193 offset:4816
  ds_write_b32 v26, v194 offset:5088
  ds_write_b32 v26, v195 offset:5360
  s_waitcnt lgkmcnt(0)
  s_barrier
  v_lshlrev_b32 v5, 2, v4
  s_lshl_b32 s47, s34, 5
  v_add_u32 v5, s47, v5
  s_movk_i32 s48, 240
  v_mul_lo_u32 v5, v5, s48
  v_lshl_add_u32 v27, v6, 1, v5
  s_waitcnt vmcnt(0)
  v_lshlrev_b32 v32, 16, v224
  v_lshlrev_b32 v33, 16, v225
  v_lshlrev_b32 v34, 16, v226
  v_lshlrev_b32 v35, 16, v227
  v_lshlrev_b32 v36, 16, v228
  v_lshlrev_b32 v37, 16, v229
  v_lshlrev_b32 v38, 16, v230
  v_mov_b32 v40, 0x3d372713
  v_mov_b32 v41, 0xc0135761
  v_mov_b32 v40, 0xbdd2d3e8
  v_mov_b32 v41, v40
  v_mov_b32 v42, 0xc0135761
  v_mov_b32 v43, v42
  v_mov_b32 v58, 1.0
  v_mov_b32 v59, 1.0
  v_mov_b32 v60, v32
  v_mov_b32 v61, v32
  v_mov_b32 v62, v33
  v_mov_b32 v63, v33
  v_mov_b32 v64, v34
  v_mov_b32 v65, v34
  v_mov_b32 v66, v35
  v_mov_b32 v67, v35
  v_mov_b32 v68, v36
  v_mov_b32 v69, v36
  v_mov_b32 v70, v37
  v_mov_b32 v71, v37
  v_mov_b32 v72, v38
  v_mov_b32 v73, v38
  v_cvt_pk_bf16_f32 v48, v152, v153
  v_cvt_pk_bf16_f32 v49, v154, v155
  v_lshlrev_b32 v152, 16, v48
  v_lshlrev_b32 v154, 16, v49
  v_and_b32 v153, 0xffff0000, v48
  v_and_b32 v155, 0xffff0000, v49
  v_pk_add_f32 v[152:153], v[152:153], v[60:61]
  v_pk_add_f32 v[154:155], v[154:155], v[60:61]
  v_cvt_pk_bf16_f32 v48, v152, v153
  v_cvt_pk_bf16_f32 v49, v154, v155
  v_lshlrev_b32 v152, 16, v48
  v_lshlrev_b32 v154, 16, v49
  v_and_b32 v153, 0xffff0000, v48
  v_and_b32 v155, 0xffff0000, v49
  v_pk_mul_f32 v[44:45], v[152:153], v[152:153]
  v_pk_mul_f32 v[46:47], v[154:155], v[154:155]
  v_pk_fma_f32 v[44:45], v[44:45], v[40:41], v[42:43]
  v_pk_fma_f32 v[46:47], v[46:47], v[40:41], v[42:43]
  v_pk_mul_f32 v[44:45], v[44:45], v[152:153]
  v_pk_mul_f32 v[46:47], v[46:47], v[154:155]
  v_exp_f32 v44, v44
  v_exp_f32 v45, v45
  v_exp_f32 v46, v46
  v_exp_f32 v47, v47
  v_pk_add_f32 v[44:45], v[44:45], v[58:59]
  v_pk_add_f32 v[46:47], v[46:47], v[58:59]
  v_rcp_f32 v44, v44
  v_rcp_f32 v45, v45
  v_rcp_f32 v46, v46
  v_rcp_f32 v47, v47
  s_nop 0
  v_pk_mul_f32 v[152:153], v[152:153], v[44:45]
  v_pk_mul_f32 v[154:155], v[154:155], v[46:47]
  v_cvt_pk_bf16_f32 v48, v152, v153
  v_cvt_pk_bf16_f32 v49, v154, v155
  ds_write_b16 v27, v48 offset:36864
  ds_write_b16_d16_hi v27, v48 offset:37104
  ds_write_b16 v27, v49 offset:37344
  ds_write_b16_d16_hi v27, v49 offset:37584
  v_cvt_pk_bf16_f32 v48, v156, v157
  v_cvt_pk_bf16_f32 v49, v158, v159
  v_lshlrev_b32 v156, 16, v48
  v_lshlrev_b32 v158, 16, v49
  v_and_b32 v157, 0xffff0000, v48
  v_and_b32 v159, 0xffff0000, v49
  v_pk_add_f32 v[156:157], v[156:157], v[62:63]
  v_pk_add_f32 v[158:159], v[158:159], v[62:63]
  v_cvt_pk_bf16_f32 v48, v156, v157
  v_cvt_pk_bf16_f32 v49, v158, v159
  v_lshlrev_b32 v156, 16, v48
  v_lshlrev_b32 v158, 16, v49
  v_and_b32 v157, 0xffff0000, v48
  v_and_b32 v159, 0xffff0000, v49
  v_pk_mul_f32 v[44:45], v[156:157], v[156:157]
  v_pk_mul_f32 v[46:47], v[158:159], v[158:159]
  v_pk_fma_f32 v[44:45], v[44:45], v[40:41], v[42:43]
  v_pk_fma_f32 v[46:47], v[46:47], v[40:41], v[42:43]
  v_pk_mul_f32 v[44:45], v[44:45], v[156:157]
  v_pk_mul_f32 v[46:47], v[46:47], v[158:159]
  v_exp_f32 v44, v44
  v_exp_f32 v45, v45
  v_exp_f32 v46, v46
  v_exp_f32 v47, v47
  v_pk_add_f32 v[44:45], v[44:45], v[58:59]
  v_pk_add_f32 v[46:47], v[46:47], v[58:59]
  v_rcp_f32 v44, v44
  v_rcp_f32 v45, v45
  v_rcp_f32 v46, v46
  v_rcp_f32 v47, v47
  s_nop 0
  v_pk_mul_f32 v[156:157], v[156:157], v[44:45]
  v_pk_mul_f32 v[158:159], v[158:159], v[46:47]
  v_cvt_pk_bf16_f32 v48, v156, v157
  v_cvt_pk_bf16_f32 v49, v158, v159
  ds_write_b16 v27, v48 offset:36896
  ds_write_b16_d16_hi v27, v48 offset:37136
  ds_write_b16 v27, v49 offset:37376
  ds_write_b16_d16_hi v27, v49 offset:37616
  v_cvt_pk_bf16_f32 v48, v160, v161
  v_cvt_pk_bf16_f32 v49, v162, v163
  v_lshlrev_b32 v160, 16, v48
  v_lshlrev_b32 v162, 16, v49
  v_and_b32 v161, 0xffff0000, v48
  v_and_b32 v163, 0xffff0000, v49
  v_pk_add_f32 v[160:161], v[160:161], v[64:65]
  v_pk_add_f32 v[162:163], v[162:163], v[64:65]
  v_cvt_pk_bf16_f32 v48, v160, v161
  v_cvt_pk_bf16_f32 v49, v162, v163
  v_lshlrev_b32 v160, 16, v48
  v_lshlrev_b32 v162, 16, v49
  v_and_b32 v161, 0xffff0000, v48
  v_and_b32 v163, 0xffff0000, v49
  v_pk_mul_f32 v[44:45], v[160:161], v[160:161]
  v_pk_mul_f32 v[46:47], v[162:163], v[162:163]
  v_pk_fma_f32 v[44:45], v[44:45], v[40:41], v[42:43]
  v_pk_fma_f32 v[46:47], v[46:47], v[40:41], v[42:43]
  v_pk_mul_f32 v[44:45], v[44:45], v[160:161]
  v_pk_mul_f32 v[46:47], v[46:47], v[162:163]
  v_exp_f32 v44, v44
  v_exp_f32 v45, v45
  v_exp_f32 v46, v46
  v_exp_f32 v47, v47
  v_pk_add_f32 v[44:45], v[44:45], v[58:59]
  v_pk_add_f32 v[46:47], v[46:47], v[58:59]
  v_rcp_f32 v44, v44
  v_rcp_f32 v45, v45
  v_rcp_f32 v46, v46
  v_rcp_f32 v47, v47
  s_nop 0
  v_pk_mul_f32 v[160:161], v[160:161], v[44:45]
  v_pk_mul_f32 v[162:163], v[162:163], v[46:47]
  v_cvt_pk_bf16_f32 v48, v160, v161
  v_cvt_pk_bf16_f32 v49, v162, v163
  ds_write_b16 v27, v48 offset:36928
  ds_write_b16_d16_hi v27, v48 offset:37168
  ds_write_b16 v27, v49 offset:37408
  ds_write_b16_d16_hi v27, v49 offset:37648
  v_cvt_pk_bf16_f32 v48, v164, v165
  v_cvt_pk_bf16_f32 v49, v166, v167
  v_lshlrev_b32 v164, 16, v48
  v_lshlrev_b32 v166, 16, v49
  v_and_b32 v165, 0xffff0000, v48
  v_and_b32 v167, 0xffff0000, v49
  v_pk_add_f32 v[164:165], v[164:165], v[66:67]
  v_pk_add_f32 v[166:167], v[166:167], v[66:67]
  v_cvt_pk_bf16_f32 v48, v164, v165
  v_cvt_pk_bf16_f32 v49, v166, v167
  v_lshlrev_b32 v164, 16, v48
  v_lshlrev_b32 v166, 16, v49
  v_and_b32 v165, 0xffff0000, v48
  v_and_b32 v167, 0xffff0000, v49
  v_pk_mul_f32 v[44:45], v[164:165], v[164:165]
  v_pk_mul_f32 v[46:47], v[166:167], v[166:167]
  v_pk_fma_f32 v[44:45], v[44:45], v[40:41], v[42:43]
  v_pk_fma_f32 v[46:47], v[46:47], v[40:41], v[42:43]
  v_pk_mul_f32 v[44:45], v[44:45], v[164:165]
  v_pk_mul_f32 v[46:47], v[46:47], v[166:167]
  v_exp_f32 v44, v44
  v_exp_f32 v45, v45
  v_exp_f32 v46, v46
  v_exp_f32 v47, v47
  v_pk_add_f32 v[44:45], v[44:45], v[58:59]
  v_pk_add_f32 v[46:47], v[46:47], v[58:59]
  v_rcp_f32 v44, v44
  v_rcp_f32 v45, v45
  v_rcp_f32 v46, v46
  v_rcp_f32 v47, v47
  s_nop 0
  v_pk_mul_f32 v[164:165], v[164:165], v[44:45]
  v_pk_mul_f32 v[166:167], v[166:167], v[46:47]
  v_cvt_pk_bf16_f32 v48, v164, v165
  v_cvt_pk_bf16_f32 v49, v166, v167
  ds_write_b16 v27, v48 offset:36960
  ds_write_b16_d16_hi v27, v48 offset:37200
  ds_write_b16 v27, v49 offset:37440
  ds_write_b16_d16_hi v27, v49 offset:37680
  v_cvt_pk_bf16_f32 v48, v168, v169
  v_cvt_pk_bf16_f32 v49, v170, v171
  v_lshlrev_b32 v168, 16, v48
  v_lshlrev_b32 v170, 16, v49
  v_and_b32 v169, 0xffff0000, v48
  v_and_b32 v171, 0xffff0000, v49
  v_pk_add_f32 v[168:169], v[168:169], v[68:69]
  v_pk_add_f32 v[170:171], v[170:171], v[68:69]
  v_cvt_pk_bf16_f32 v48, v168, v169
  v_cvt_pk_bf16_f32 v49, v170, v171
  v_lshlrev_b32 v168, 16, v48
  v_lshlrev_b32 v170, 16, v49
  v_and_b32 v169, 0xffff0000, v48
  v_and_b32 v171, 0xffff0000, v49
  v_pk_mul_f32 v[44:45], v[168:169], v[168:169]
  v_pk_mul_f32 v[46:47], v[170:171], v[170:171]
  v_pk_fma_f32 v[44:45], v[44:45], v[40:41], v[42:43]
  v_pk_fma_f32 v[46:47], v[46:47], v[40:41], v[42:43]
  v_pk_mul_f32 v[44:45], v[44:45], v[168:169]
  v_pk_mul_f32 v[46:47], v[46:47], v[170:171]
  v_exp_f32 v44, v44
  v_exp_f32 v45, v45
  v_exp_f32 v46, v46
  v_exp_f32 v47, v47
  v_pk_add_f32 v[44:45], v[44:45], v[58:59]
  v_pk_add_f32 v[46:47], v[46:47], v[58:59]
  v_rcp_f32 v44, v44
  v_rcp_f32 v45, v45
  v_rcp_f32 v46, v46
  v_rcp_f32 v47, v47
  s_nop 0
  v_pk_mul_f32 v[168:169], v[168:169], v[44:45]
  v_pk_mul_f32 v[170:171], v[170:171], v[46:47]
  v_cvt_pk_bf16_f32 v48, v168, v169
  v_cvt_pk_bf16_f32 v49, v170, v171
  ds_write_b16 v27, v48 offset:36992
  ds_write_b16_d16_hi v27, v48 offset:37232
  ds_write_b16 v27, v49 offset:37472
  ds_write_b16_d16_hi v27, v49 offset:37712
  v_cvt_pk_bf16_f32 v48, v172, v173
  v_cvt_pk_bf16_f32 v49, v174, v175
  v_lshlrev_b32 v172, 16, v48
  v_lshlrev_b32 v174, 16, v49
  v_and_b32 v173, 0xffff0000, v48
  v_and_b32 v175, 0xffff0000, v49
  v_pk_add_f32 v[172:173], v[172:173], v[70:71]
  v_pk_add_f32 v[174:175], v[174:175], v[70:71]
  v_cvt_pk_bf16_f32 v48, v172, v173
  v_cvt_pk_bf16_f32 v49, v174, v175
  v_lshlrev_b32 v172, 16, v48
  v_lshlrev_b32 v174, 16, v49
  v_and_b32 v173, 0xffff0000, v48
  v_and_b32 v175, 0xffff0000, v49
  v_pk_mul_f32 v[44:45], v[172:173], v[172:173]
  v_pk_mul_f32 v[46:47], v[174:175], v[174:175]
  v_pk_fma_f32 v[44:45], v[44:45], v[40:41], v[42:43]
  v_pk_fma_f32 v[46:47], v[46:47], v[40:41], v[42:43]
  v_pk_mul_f32 v[44:45], v[44:45], v[172:173]
  v_pk_mul_f32 v[46:47], v[46:47], v[174:175]
  v_exp_f32 v44, v44
  v_exp_f32 v45, v45
  v_exp_f32 v46, v46
  v_exp_f32 v47, v47
  v_pk_add_f32 v[44:45], v[44:45], v[58:59]
  v_pk_add_f32 v[46:47], v[46:47], v[58:59]
  v_rcp_f32 v44, v44
  v_rcp_f32 v45, v45
  v_rcp_f32 v46, v46
  v_rcp_f32 v47, v47
  s_nop 0
  v_pk_mul_f32 v[172:173], v[172:173], v[44:45]
  v_pk_mul_f32 v[174:175], v[174:175], v[46:47]
  v_cvt_pk_bf16_f32 v48, v172, v173
  v_cvt_pk_bf16_f32 v49, v174, v175
  ds_write_b16 v27, v48 offset:37024
  ds_write_b16_d16_hi v27, v48 offset:37264
  ds_write_b16 v27, v49 offset:37504
  ds_write_b16_d16_hi v27, v49 offset:37744
  v_cvt_pk_bf16_f32 v48, v176, v177
  v_cvt_pk_bf16_f32 v49, v178, v179
  v_lshlrev_b32 v176, 16, v48
  v_lshlrev_b32 v178, 16, v49
  v_and_b32 v177, 0xffff0000, v48
  v_and_b32 v179, 0xffff0000, v49
  v_pk_add_f32 v[176:177], v[176:177], v[72:73]
  v_pk_add_f32 v[178:179], v[178:179], v[72:73]
  v_cvt_pk_bf16_f32 v48, v176, v177
  v_cvt_pk_bf16_f32 v49, v178, v179
  v_lshlrev_b32 v176, 16, v48
  v_lshlrev_b32 v178, 16, v49
  v_and_b32 v177, 0xffff0000, v48
  v_and_b32 v179, 0xffff0000, v49
  v_pk_mul_f32 v[44:45], v[176:177], v[176:177]
  v_pk_mul_f32 v[46:47], v[178:179], v[178:179]
  v_pk_fma_f32 v[44:45], v[44:45], v[40:41], v[42:43]
  v_pk_fma_f32 v[46:47], v[46:47], v[40:41], v[42:43]
  v_pk_mul_f32 v[44:45], v[44:45], v[176:177]
  v_pk_mul_f32 v[46:47], v[46:47], v[178:179]
  v_exp_f32 v44, v44
  v_exp_f32 v45, v45
  v_exp_f32 v46, v46
  v_exp_f32 v47, v47
  v_pk_add_f32 v[44:45], v[44:45], v[58:59]
  v_pk_add_f32 v[46:47], v[46:47], v[58:59]
  v_rcp_f32 v44, v44
  v_rcp_f32 v45, v45
  v_rcp_f32 v46, v46
  v_rcp_f32 v47, v47
  s_nop 0
  v_pk_mul_f32 v[176:177], v[176:177], v[44:45]
  v_pk_mul_f32 v[178:179], v[178:179], v[46:47]
  v_cvt_pk_bf16_f32 v48, v176, v177
  v_cvt_pk_bf16_f32 v49, v178, v179
  ds_write_b16 v27, v48 offset:37056
  ds_write_b16_d16_hi v27, v48 offset:37296
  ds_write_b16 v27, v49 offset:37536
  ds_write_b16_d16_hi v27, v49 offset:37776
  v_cvt_pk_bf16_f32 v48, v196, v197
  v_cvt_pk_bf16_f32 v49, v198, v199
  v_lshlrev_b32 v196, 16, v48
  v_lshlrev_b32 v198, 16, v49
  v_and_b32 v197, 0xffff0000, v48
  v_and_b32 v199, 0xffff0000, v49
  v_pk_add_f32 v[196:197], v[196:197], v[60:61]
  v_pk_add_f32 v[198:199], v[198:199], v[60:61]
  v_cvt_pk_bf16_f32 v48, v196, v197
  v_cvt_pk_bf16_f32 v49, v198, v199
  v_lshlrev_b32 v196, 16, v48
  v_lshlrev_b32 v198, 16, v49
  v_and_b32 v197, 0xffff0000, v48
  v_and_b32 v199, 0xffff0000, v49
  v_pk_mul_f32 v[44:45], v[196:197], v[196:197]
  v_pk_mul_f32 v[46:47], v[198:199], v[198:199]
  v_pk_fma_f32 v[44:45], v[44:45], v[40:41], v[42:43]
  v_pk_fma_f32 v[46:47], v[46:47], v[40:41], v[42:43]
  v_pk_mul_f32 v[44:45], v[44:45], v[196:197]
  v_pk_mul_f32 v[46:47], v[46:47], v[198:199]
  v_exp_f32 v44, v44
  v_exp_f32 v45, v45
  v_exp_f32 v46, v46
  v_exp_f32 v47, v47
  v_pk_add_f32 v[44:45], v[44:45], v[58:59]
  v_pk_add_f32 v[46:47], v[46:47], v[58:59]
  v_rcp_f32 v44, v44
  v_rcp_f32 v45, v45
  v_rcp_f32 v46, v46
  v_rcp_f32 v47, v47
  s_nop 0
  v_pk_mul_f32 v[196:197], v[196:197], v[44:45]
  v_pk_mul_f32 v[198:199], v[198:199], v[46:47]
  v_cvt_pk_bf16_f32 v48, v196, v197
  v_cvt_pk_bf16_f32 v49, v198, v199
  ds_write_b16 v27, v48 offset:40704
  ds_write_b16_d16_hi v27, v48 offset:40944
  ds_write_b16 v27, v49 offset:41184
  ds_write_b16_d16_hi v27, v49 offset:41424
  v_cvt_pk_bf16_f32 v48, v200, v201
  v_cvt_pk_bf16_f32 v49, v202, v203
  v_lshlrev_b32 v200, 16, v48
  v_lshlrev_b32 v202, 16, v49
  v_and_b32 v201, 0xffff0000, v48
  v_and_b32 v203, 0xffff0000, v49
  v_pk_add_f32 v[200:201], v[200:201], v[62:63]
  v_pk_add_f32 v[202:203], v[202:203], v[62:63]
  v_cvt_pk_bf16_f32 v48, v200, v201
  v_cvt_pk_bf16_f32 v49, v202, v203
  v_lshlrev_b32 v200, 16, v48
  v_lshlrev_b32 v202, 16, v49
  v_and_b32 v201, 0xffff0000, v48
  v_and_b32 v203, 0xffff0000, v49
  v_pk_mul_f32 v[44:45], v[200:201], v[200:201]
  v_pk_mul_f32 v[46:47], v[202:203], v[202:203]
  v_pk_fma_f32 v[44:45], v[44:45], v[40:41], v[42:43]
  v_pk_fma_f32 v[46:47], v[46:47], v[40:41], v[42:43]
  v_pk_mul_f32 v[44:45], v[44:45], v[200:201]
  v_pk_mul_f32 v[46:47], v[46:47], v[202:203]
  v_exp_f32 v44, v44
  v_exp_f32 v45, v45
  v_exp_f32 v46, v46
  v_exp_f32 v47, v47
  v_pk_add_f32 v[44:45], v[44:45], v[58:59]
  v_pk_add_f32 v[46:47], v[46:47], v[58:59]
  v_rcp_f32 v44, v44
  v_rcp_f32 v45, v45
  v_rcp_f32 v46, v46
  v_rcp_f32 v47, v47
  s_nop 0
  v_pk_mul_f32 v[200:201], v[200:201], v[44:45]
  v_pk_mul_f32 v[202:203], v[202:203], v[46:47]
  v_cvt_pk_bf16_f32 v48, v200, v201
  v_cvt_pk_bf16_f32 v49, v202, v203
  ds_write_b16 v27, v48 offset:40736
  ds_write_b16_d16_hi v27, v48 offset:40976
  ds_write_b16 v27, v49 offset:41216
  ds_write_b16_d16_hi v27, v49 offset:41456
  v_cvt_pk_bf16_f32 v48, v204, v205
  v_cvt_pk_bf16_f32 v49, v206, v207
  v_lshlrev_b32 v204, 16, v48
  v_lshlrev_b32 v206, 16, v49
  v_and_b32 v205, 0xffff0000, v48
  v_and_b32 v207, 0xffff0000, v49
  v_pk_add_f32 v[204:205], v[204:205], v[64:65]
  v_pk_add_f32 v[206:207], v[206:207], v[64:65]
  v_cvt_pk_bf16_f32 v48, v204, v205
  v_cvt_pk_bf16_f32 v49, v206, v207
  v_lshlrev_b32 v204, 16, v48
  v_lshlrev_b32 v206, 16, v49
  v_and_b32 v205, 0xffff0000, v48
  v_and_b32 v207, 0xffff0000, v49
  v_pk_mul_f32 v[44:45], v[204:205], v[204:205]
  v_pk_mul_f32 v[46:47], v[206:207], v[206:207]
  v_pk_fma_f32 v[44:45], v[44:45], v[40:41], v[42:43]
  v_pk_fma_f32 v[46:47], v[46:47], v[40:41], v[42:43]
  v_pk_mul_f32 v[44:45], v[44:45], v[204:205]
  v_pk_mul_f32 v[46:47], v[46:47], v[206:207]
  v_exp_f32 v44, v44
  v_exp_f32 v45, v45
  v_exp_f32 v46, v46
  v_exp_f32 v47, v47
  v_pk_add_f32 v[44:45], v[44:45], v[58:59]
  v_pk_add_f32 v[46:47], v[46:47], v[58:59]
  v_rcp_f32 v44, v44
  v_rcp_f32 v45, v45
  v_rcp_f32 v46, v46
  v_rcp_f32 v47, v47
  s_nop 0
  v_pk_mul_f32 v[204:205], v[204:205], v[44:45]
  v_pk_mul_f32 v[206:207], v[206:207], v[46:47]
  v_cvt_pk_bf16_f32 v48, v204, v205
  v_cvt_pk_bf16_f32 v49, v206, v207
  ds_write_b16 v27, v48 offset:40768
  ds_write_b16_d16_hi v27, v48 offset:41008
  ds_write_b16 v27, v49 offset:41248
  ds_write_b16_d16_hi v27, v49 offset:41488
  v_cvt_pk_bf16_f32 v48, v208, v209
  v_cvt_pk_bf16_f32 v49, v210, v211
  v_lshlrev_b32 v208, 16, v48
  v_lshlrev_b32 v210, 16, v49
  v_and_b32 v209, 0xffff0000, v48
  v_and_b32 v211, 0xffff0000, v49
  v_pk_add_f32 v[208:209], v[208:209], v[66:67]
  v_pk_add_f32 v[210:211], v[210:211], v[66:67]
  v_cvt_pk_bf16_f32 v48, v208, v209
  v_cvt_pk_bf16_f32 v49, v210, v211
  v_lshlrev_b32 v208, 16, v48
  v_lshlrev_b32 v210, 16, v49
  v_and_b32 v209, 0xffff0000, v48
  v_and_b32 v211, 0xffff0000, v49
  v_pk_mul_f32 v[44:45], v[208:209], v[208:209]
  v_pk_mul_f32 v[46:47], v[210:211], v[210:211]
  v_pk_fma_f32 v[44:45], v[44:45], v[40:41], v[42:43]
  v_pk_fma_f32 v[46:47], v[46:47], v[40:41], v[42:43]
  v_pk_mul_f32 v[44:45], v[44:45], v[208:209]
  v_pk_mul_f32 v[46:47], v[46:47], v[210:211]
  v_exp_f32 v44, v44
  v_exp_f32 v45, v45
  v_exp_f32 v46, v46
  v_exp_f32 v47, v47
  v_pk_add_f32 v[44:45], v[44:45], v[58:59]
  v_pk_add_f32 v[46:47], v[46:47], v[58:59]
  v_rcp_f32 v44, v44
  v_rcp_f32 v45, v45
  v_rcp_f32 v46, v46
  v_rcp_f32 v47, v47
  s_nop 0
  v_pk_mul_f32 v[208:209], v[208:209], v[44:45]
  v_pk_mul_f32 v[210:211], v[210:211], v[46:47]
  v_cvt_pk_bf16_f32 v48, v208, v209
  v_cvt_pk_bf16_f32 v49, v210, v211
  ds_write_b16 v27, v48 offset:40800
  ds_write_b16_d16_hi v27, v48 offset:41040
  ds_write_b16 v27, v49 offset:41280
  ds_write_b16_d16_hi v27, v49 offset:41520
  v_cvt_pk_bf16_f32 v48, v212, v213
  v_cvt_pk_bf16_f32 v49, v214, v215
  v_lshlrev_b32 v212, 16, v48
  v_lshlrev_b32 v214, 16, v49
  v_and_b32 v213, 0xffff0000, v48
  v_and_b32 v215, 0xffff0000, v49
  v_pk_add_f32 v[212:213], v[212:213], v[68:69]
  v_pk_add_f32 v[214:215], v[214:215], v[68:69]
  v_cvt_pk_bf16_f32 v48, v212, v213
  v_cvt_pk_bf16_f32 v49, v214, v215
  v_lshlrev_b32 v212, 16, v48
  v_lshlrev_b32 v214, 16, v49
  v_and_b32 v213, 0xffff0000, v48
  v_and_b32 v215, 0xffff0000, v49
  v_pk_mul_f32 v[44:45], v[212:213], v[212:213]
  v_pk_mul_f32 v[46:47], v[214:215], v[214:215]
  v_pk_fma_f32 v[44:45], v[44:45], v[40:41], v[42:43]
  v_pk_fma_f32 v[46:47], v[46:47], v[40:41], v[42:43]
  v_pk_mul_f32 v[44:45], v[44:45], v[212:213]
  v_pk_mul_f32 v[46:47], v[46:47], v[214:215]
  v_exp_f32 v44, v44
  v_exp_f32 v45, v45
  v_exp_f32 v46, v46
  v_exp_f32 v47, v47
  v_pk_add_f32 v[44:45], v[44:45], v[58:59]
  v_pk_add_f32 v[46:47], v[46:47], v[58:59]
  v_rcp_f32 v44, v44
  v_rcp_f32 v45, v45
  v_rcp_f32 v46, v46
  v_rcp_f32 v47, v47
  s_nop 0
  v_pk_mul_f32 v[212:213], v[212:213], v[44:45]
  v_pk_mul_f32 v[214:215], v[214:215], v[46:47]
  v_cvt_pk_bf16_f32 v48, v212, v213
  v_cvt_pk_bf16_f32 v49, v214, v215
  ds_write_b16 v27, v48 offset:40832
  ds_write_b16_d16_hi v27, v48 offset:41072
  ds_write_b16 v27, v49 offset:41312
  ds_write_b16_d16_hi v27, v49 offset:41552
  v_cvt_pk_bf16_f32 v48, v216, v217
  v_cvt_pk_bf16_f32 v49, v218, v219
  v_lshlrev_b32 v216, 16, v48
  v_lshlrev_b32 v218, 16, v49
  v_and_b32 v217, 0xffff0000, v48
  v_and_b32 v219, 0xffff0000, v49
  v_pk_add_f32 v[216:217], v[216:217], v[70:71]
  v_pk_add_f32 v[218:219], v[218:219], v[70:71]
  v_cvt_pk_bf16_f32 v48, v216, v217
  v_cvt_pk_bf16_f32 v49, v218, v219
  v_lshlrev_b32 v216, 16, v48
  v_lshlrev_b32 v218, 16, v49
  v_and_b32 v217, 0xffff0000, v48
  v_and_b32 v219, 0xffff0000, v49
  v_pk_mul_f32 v[44:45], v[216:217], v[216:217]
  v_pk_mul_f32 v[46:47], v[218:219], v[218:219]
  v_pk_fma_f32 v[44:45], v[44:45], v[40:41], v[42:43]
  v_pk_fma_f32 v[46:47], v[46:47], v[40:41], v[42:43]
  v_pk_mul_f32 v[44:45], v[44:45], v[216:217]
  v_pk_mul_f32 v[46:47], v[46:47], v[218:219]
  v_exp_f32 v44, v44
  v_exp_f32 v45, v45
  v_exp_f32 v46, v46
  v_exp_f32 v47, v47
  v_pk_add_f32 v[44:45], v[44:45], v[58:59]
  v_pk_add_f32 v[46:47], v[46:47], v[58:59]
  v_rcp_f32 v44, v44
  v_rcp_f32 v45, v45
  v_rcp_f32 v46, v46
  v_rcp_f32 v47, v47
  s_nop 0
  v_pk_mul_f32 v[216:217], v[216:217], v[44:45]
  v_pk_mul_f32 v[218:219], v[218:219], v[46:47]
  v_cvt_pk_bf16_f32 v48, v216, v217
  v_cvt_pk_bf16_f32 v49, v218, v219
  ds_write_b16 v27, v48 offset:40864
  ds_write_b16_d16_hi v27, v48 offset:41104
  ds_write_b16 v27, v49 offset:41344
  ds_write_b16_d16_hi v27, v49 offset:41584
  v_cvt_pk_bf16_f32 v48, v220, v221
  v_cvt_pk_bf16_f32 v49, v222, v223
  v_lshlrev_b32 v220, 16, v48
  v_lshlrev_b32 v222, 16, v49
  v_and_b32 v221, 0xffff0000, v48
  v_and_b32 v223, 0xffff0000, v49
  v_pk_add_f32 v[220:221], v[220:221], v[72:73]
  v_pk_add_f32 v[222:223], v[222:223], v[72:73]
  v_cvt_pk_bf16_f32 v48, v220, v221
  v_cvt_pk_bf16_f32 v49, v222, v223
  v_lshlrev_b32 v220, 16, v48
  v_lshlrev_b32 v222, 16, v49
  v_and_b32 v221, 0xffff0000, v48
  v_and_b32 v223, 0xffff0000, v49
  v_pk_mul_f32 v[44:45], v[220:221], v[220:221]
  v_pk_mul_f32 v[46:47], v[222:223], v[222:223]
  v_pk_fma_f32 v[44:45], v[44:45], v[40:41], v[42:43]
  v_pk_fma_f32 v[46:47], v[46:47], v[40:41], v[42:43]
  v_pk_mul_f32 v[44:45], v[44:45], v[220:221]
  v_pk_mul_f32 v[46:47], v[46:47], v[222:223]
  v_exp_f32 v44, v44
  v_exp_f32 v45, v45
  v_exp_f32 v46, v46
  v_exp_f32 v47, v47
  v_pk_add_f32 v[44:45], v[44:45], v[58:59]
  v_pk_add_f32 v[46:47], v[46:47], v[58:59]
  v_rcp_f32 v44, v44
  v_rcp_f32 v45, v45
  v_rcp_f32 v46, v46
  v_rcp_f32 v47, v47
  s_nop 0
  v_pk_mul_f32 v[220:221], v[220:221], v[44:45]
  v_pk_mul_f32 v[222:223], v[222:223], v[46:47]
  v_cvt_pk_bf16_f32 v48, v220, v221
  v_cvt_pk_bf16_f32 v49, v222, v223
  ds_write_b16 v27, v48 offset:40896
  ds_write_b16_d16_hi v27, v48 offset:41136
  ds_write_b16 v27, v49 offset:41376
  ds_write_b16_d16_hi v27, v49 offset:41616
  s_waitcnt lgkmcnt(0)
  s_barrier
  s_mul_i32 s47, s35, 720896
  s_mul_i32 s48, s36, 224
  s_add_u32 s47, s47, s48
  s_add_u32 s47, s47, 8390656
  s_mov_b32 s48, 0x12492493
  v_add_u32 v5, 0, v0
  v_mul_hi_u32 v6, v5, s48
  v_mul_u32_u24 v7, 14, v6
  v_sub_u32 v7, v5, v7
  s_movk_i32 s49, 240
  v_mul_lo_u32 v8, v6, s49
  v_lshl_add_u32 v8, v7, 4, v8
  ds_read_b128 v[44:47], v8 offset:36864
  s_movk_i32 s49, 5632
  v_mul_lo_u32 v8, v6, s49
  v_lshl_add_u32 v72, v7, 4, v8
  v_add_u32 v5, 256, v0
  v_mul_hi_u32 v6, v5, s48
  v_mul_u32_u24 v7, 14, v6
  v_sub_u32 v7, v5, v7
  s_movk_i32 s49, 240
  v_mul_lo_u32 v8, v6, s49
  v_lshl_add_u32 v8, v7, 4, v8
  ds_read_b128 v[48:51], v8 offset:36864
  s_movk_i32 s49, 5632
  v_mul_lo_u32 v8, v6, s49
  v_lshl_add_u32 v73, v7, 4, v8
  v_add_u32 v5, 512, v0
  v_mul_hi_u32 v6, v5, s48
  v_mul_u32_u24 v7, 14, v6
  v_sub_u32 v7, v5, v7
  s_movk_i32 s49, 240
  v_mul_lo_u32 v8, v6, s49
  v_lshl_add_u32 v8, v7, 4, v8
  ds_read_b128 v[52:55], v8 offset:36864
  s_movk_i32 s49, 5632
  v_mul_lo_u32 v8, v6, s49
  v_lshl_add_u32 v74, v7, 4, v8
  v_add_u32 v5, 768, v0
  v_mul_hi_u32 v6, v5, s48
  v_mul_u32_u24 v7, 14, v6
  v_sub_u32 v7, v5, v7
  s_movk_i32 s49, 240
  v_mul_lo_u32 v8, v6, s49
  v_lshl_add_u32 v8, v7, 4, v8
  ds_read_b128 v[56:59], v8 offset:36864
  s_movk_i32 s49, 5632
  v_mul_lo_u32 v8, v6, s49
  v_lshl_add_u32 v75, v7, 4, v8
  v_add_u32 v5, 1024, v0
  v_mul_hi_u32 v6, v5, s48
  v_mul_u32_u24 v7, 14, v6
  v_sub_u32 v7, v5, v7
  s_movk_i32 s49, 240
  v_mul_lo_u32 v8, v6, s49
  v_lshl_add_u32 v8, v7, 4, v8
  ds_read_b128 v[60:63], v8 offset:36864
  s_movk_i32 s49, 5632
  v_mul_lo_u32 v8, v6, s49
  v_lshl_add_u32 v76, v7, 4, v8
  v_add_u32 v5, 1280, v0
  v_mul_hi_u32 v6, v5, s48
  v_mul_u32_u24 v7, 14, v6
  v_sub_u32 v7, v5, v7
  s_movk_i32 s49, 240
  v_mul_lo_u32 v8, v6, s49
  v_lshl_add_u32 v8, v7, 4, v8
  ds_read_b128 v[64:67], v8 offset:36864
  s_movk_i32 s49, 5632
  v_mul_lo_u32 v8, v6, s49
  v_lshl_add_u32 v77, v7, 4, v8
  v_add_u32 v5, 1536, v0
  v_mul_hi_u32 v6, v5, s48
  v_mul_u32_u24 v7, 14, v6
  v_sub_u32 v7, v5, v7
  s_movk_i32 s49, 240
  v_mul_lo_u32 v8, v6, s49
  v_lshl_add_u32 v8, v7, 4, v8
  ds_read_b128 v[68:71], v8 offset:36864
  s_movk_i32 s49, 5632
  v_mul_lo_u32 v8, v6, s49
  v_lshl_add_u32 v78, v7, 4, v8
  s_waitcnt lgkmcnt(0)
  buffer_store_dwordx4 v[44:47], v72, s[20:23], s47 offen
  buffer_store_dwordx4 v[48:51], v73, s[20:23], s47 offen
  buffer_store_dwordx4 v[52:55], v74, s[20:23], s47 offen
  buffer_store_dwordx4 v[56:59], v75, s[20:23], s47 offen
  buffer_store_dwordx4 v[60:63], v76, s[20:23], s47 offen
  buffer_store_dwordx4 v[64:67], v77, s[20:23], s47 offen
  buffer_store_dwordx4 v[68:71], v78, s[20:23], s47 offen
  s_waitcnt vmcnt(0)
K1_END:
  s_endpgm
.p2align 8
.globl k2_kernel
.type k2_kernel,@function
k2_kernel:
  s_cmp_ge_u32 s2, 256
  s_cbranch_scc1 K2_END
  s_load_dwordx2 s[24:25], s[0:1], 8
  s_load_dwordx2 s[26:27], s[0:1], 16
  s_load_dwordx2 s[28:29], s[0:1], 56
  s_load_dwordx2 s[32:33], s[0:1], 136
  s_and_b32 s34, s2, 1
  s_lshr_b32 s35, s2, 1
  s_and_b32 s35, s35, 7
  s_lshr_b32 s36, s2, 4
  s_waitcnt lgkmcnt(0)
  s_mov_b32 s20, s32
  s_and_b32 s21, s33, 0xffff
  s_mov_b32 s22, 33554432
  s_mov_b32 s23, 0x00020000
  s_lshl_b32 s47, s34, 8
  v_add_u32 v2, s47, v0
  v_lshlrev_b32 v5, 1, v2
  s_mov_b32 s8, s24
  s_and_b32 s9, s25, 0xffff
  s_mov_b32 s10, 1024
  s_mov_b32 s11, 0x00020000
  buffer_load_ushort v80, v5, s[8:11], 0 offen
  s_mov_b32 s8, s26
  s_and_b32 s9, s27, 0xffff
  s_mov_b32 s10, 1024
  s_mov_b32 s11, 0x00020000
  buffer_load_ushort v81, v5, s[8:11], 0 offen
  s_mov_b32 s8, s28
  s_and_b32 s9, s29, 0xffff
  s_mov_b32 s10, 1024
  s_mov_b32 s11, 0x00020000
  buffer_load_ushort v82, v5, s[8:11], 0 offen
  v_lshlrev_b32 v5, 3, v2
  s_mov_b32 s47, 25165824
  buffer_load_dwordx2 v[84:85], v5, s[20:23], s47 offen
  s_add_u32 s47, s47, 4096
  buffer_load_dwordx2 v[86:87], v5, s[20:23], s47 offen
  s_add_u32 s47, s47, 4096
  buffer_load_dwordx2 v[88:89], v5, s[20:23], s47 offen
  s_add_u32 s47, s47, 4096
  buffer_load_dwordx2 v[90:91], v5, s[20:23], s47 offen
  s_add_u32 s47, s47, 4096
  buffer_load_dwordx2 v[92:93], v5, s[20:23], s47 offen
  s_add_u32 s47, s47, 4096
  buffer_load_dwordx2 v[94:95], v5, s[20:23], s47 offen
  s_add_u32 s47, s47, 4096
  buffer_load_dwordx2 v[96:97], v5, s[20:23], s47 offen
  s_add_u32 s47, s47, 4096
  buffer_load_dwordx2 v[98:99], v5, s[20:23], s47 offen
  s_add_u32 s47, s47, 4096
  buffer_load_dwordx2 v[100:101], v5, s[20:23], s47 offen
  s_add_u32 s47, s47, 4096
  buffer_load_dwordx2 v[102:103], v5, s[20:23], s47 offen
  s_add_u32 s47, s47, 4096
  buffer_load_dwordx2 v[104:105], v5, s[20:23], s47 offen
  s_add_u32 s47, s47, 4096
  buffer_load_dwordx2 v[106:107], v5, s[20:23], s47 offen
  s_add_u32 s47, s47, 4096
  buffer_load_dwordx2 v[108:109], v5, s[20:23], s47 offen
  s_add_u32 s47, s47, 4096
  buffer_load_dwordx2 v[110:111], v5, s[20:23], s47 offen
  s_add_u32 s47, s47, 4096
  buffer_load_dwordx2 v[112:113], v5, s[20:23], s47 offen
  s_add_u32 s47, s47, 4096
  s_lshl_b32 s47, s36, 18
  s_lshl_b32 s48, s35, 15
  s_add_u32 s47, s47, s48
  s_add_u32 s48, s47, 4194304
  v_lshlrev_b32 v6, 2, v2
  v_mov_b32 v7, v6
  buffer_load_dword v116, v7, s[20:23], s47 offen offset:0
  buffer_load_dword v132, v7, s[20:23], s48 offen offset:0
  buffer_load_dword v117, v7, s[20:23], s47 offen offset:2048
  buffer_load_dword v133, v7, s[20:23], s48 offen offset:2048
  v_add_u32 v7, 4096, v7
  buffer_load_dword v118, v7, s[20:23], s47 offen offset:0
  buffer_load_dword v134, v7, s[20:23], s48 offen offset:0
  buffer_load_dword v119, v7, s[20:23], s47 offen offset:2048
  buffer_load_dword v135, v7, s[20:23], s48 offen offset:2048
  v_add_u32 v7, 4096, v7
  buffer_load_dword v120, v7, s[20:23], s47 offen offset:0
  buffer_load_dword v136, v7, s[20:23], s48 offen offset:0
  buffer_load_dword v121, v7, s[20:23], s47 offen offset:2048
  buffer_load_dword v137, v7, s[20:23], s48 offen offset:2048
  v_add_u32 v7, 4096, v7
  buffer_load_dword v122, v7, s[20:23], s47 offen offset:0
  buffer_load_dword v138, v7, s[20:23], s48 offen offset:0
  buffer_load_dword v123, v7, s[20:23], s47 offen offset:2048
  buffer_load_dword v139, v7, s[20:23], s48 offen offset:2048
  v_add_u32 v7, 4096, v7
  buffer_load_dword v124, v7, s[20:23], s47 offen offset:0
  buffer_load_dword v140, v7, s[20:23], s48 offen offset:0
  buffer_load_dword v125, v7, s[20:23], s47 offen offset:2048
  buffer_load_dword v141, v7, s[20:23], s48 offen offset:2048
  v_add_u32 v7, 4096, v7
  buffer_load_dword v126, v7, s[20:23], s47 offen offset:0
  buffer_load_dword v142, v7, s[20:23], s48 offen offset:0
  buffer_load_dword v127, v7, s[20:23], s47 offen offset:2048
  buffer_load_dword v143, v7, s[20:23], s48 offen offset:2048
  v_add_u32 v7, 4096, v7
  buffer_load_dword v128, v7, s[20:23], s47 offen offset:0
  buffer_load_dword v144, v7, s[20:23], s48 offen offset:0
  buffer_load_dword v129, v7, s[20:23], s47 offen offset:2048
  buffer_load_dword v145, v7, s[20:23], s48 offen offset:2048
  v_add_u32 v7, 4096, v7
  buffer_load_dword v130, v7, s[20:23], s47 offen offset:0
  buffer_load_dword v146, v7, s[20:23], s48 offen offset:0
  buffer_load_dword v131, v7, s[20:23], s47 offen offset:2048
  buffer_load_dword v147, v7, s[20:23], s48 offen offset:2048
  s_waitcnt vmcnt(32)
  v_lshlrev_b32 v80, 16, v80
  v_lshlrev_b32 v81, 16, v81
  v_lshlrev_b32 v82, 16, v82
  v_mov_b32 v6, 0x3fb8aa3b
  v_mul_f32 v82, v82, v6
  v_exp_f32 v82, v82
  s_nop 0
  v_cvt_pk_bf16_f32 v82, v82, v82
  v_lshlrev_b32 v82, 16, v82
  v_mul_f32 v83, v82, v80
  v_mul_f32 v3, v82, v81
  v_mul_f32 v83, v83, v6
  v_mov_b32 v6, 0x3e22f983
  v_mul_f32 v3, v3, v6
  v_exp_f32 v8, v83
  v_mov_b32 v9, v3
  v_fract_f32 v9, v9
  v_cos_f32 v150, v9
  v_sin_f32 v151, v9
  s_nop 0
  v_mul_f32 v150, v150, v8
  v_mul_f32 v151, v151, v8
  v_mov_b32 v9, 0x43000000
  v_mul_f32 v8, v9, v83
  v_exp_f32 v8, v8
  v_mov_b32 v9, 0x43000000
  v_mul_f32 v9, v9, v3
  v_fract_f32 v9, v9
  v_cos_f32 v152, v9
  v_sin_f32 v153, v9
  s_nop 0
  v_mul_f32 v152, v152, v8
  v_mul_f32 v153, v153, v8
  s_lshl_b32 s49, s35, 4
  v_cvt_f32_u32 v4, s49
  v_mul_f32 v10, v83, v4
  v_mul_f32 v11, v3, v4
  v_exp_f32 v8, v10
  v_mov_b32 v9, v11
  v_fract_f32 v9, v9
  v_cos_f32 v154, v9
  v_sin_f32 v155, v9
  s_nop 0
  v_mul_f32 v154, v154, v8
  v_mul_f32 v155, v155, v8
  v_mov_b32 v156, 0
  v_mov_b32 v157, 0
  s_cmp_lt_u32 0, s36
  s_cbranch_scc0 K2_HD
  v_fma_f32 v8, v152, v156, v84
  v_fma_f32 v8, -v153, v157, v8
  v_fma_f32 v9, v152, v157, v85
  v_fma_f32 v157, v153, v156, v9
  v_mov_b32 v156, v8
  s_cmp_lt_u32 1, s36
  s_cbranch_scc0 K2_HD
  v_fma_f32 v8, v152, v156, v86
  v_fma_f32 v8, -v153, v157, v8
  v_fma_f32 v9, v152, v157, v87
  v_fma_f32 v157, v153, v156, v9
  v_mov_b32 v156, v8
  s_cmp_lt_u32 2, s36
  s_cbranch_scc0 K2_HD
  v_fma_f32 v8, v152, v156, v88
  v_fma_f32 v8, -v153, v157, v8
  v_fma_f32 v9, v152, v157, v89
  v_fma_f32 v157, v153, v156, v9
  v_mov_b32 v156, v8
  s_cmp_lt_u32 3, s36
  s_cbranch_scc0 K2_HD
  v_fma_f32 v8, v152, v156, v90
  v_fma_f32 v8, -v153, v157, v8
  v_fma_f32 v9, v152, v157, v91
  v_fma_f32 v157, v153, v156, v9
  v_mov_b32 v156, v8
  s_cmp_lt_u32 4, s36
  s_cbranch_scc0 K2_HD
  v_fma_f32 v8, v152, v156, v92
  v_fma_f32 v8, -v153, v157, v8
  v_fma_f32 v9, v152, v157, v93
  v_fma_f32 v157, v153, v156, v9
  v_mov_b32 v156, v8
  s_cmp_lt_u32 5, s36
  s_cbranch_scc0 K2_HD
  v_fma_f32 v8, v152, v156, v94
  v_fma_f32 v8, -v153, v157, v8
  v_fma_f32 v9, v152, v157, v95
  v_fma_f32 v157, v153, v156, v9
  v_mov_b32 v156, v8
  s_cmp_lt_u32 6, s36
  s_cbranch_scc0 K2_HD
  v_fma_f32 v8, v152, v156, v96
  v_fma_f32 v8, -v153, v157, v8
  v_fma_f32 v9, v152, v157, v97
  v_fma_f32 v157, v153, v156, v9
  v_mov_b32 v156, v8
  s_cmp_lt_u32 7, s36
  s_cbranch_scc0 K2_HD
  v_fma_f32 v8, v152, v156, v98
  v_fma_f32 v8, -v153, v157, v8
  v_fma_f32 v9, v152, v157, v99
  v_fma_f32 v157, v153, v156, v9
  v_mov_b32 v156, v8
  s_cmp_lt_u32 8, s36
  s_cbranch_scc0 K2_HD
  v_fma_f32 v8, v152, v156, v100
  v_fma_f32 v8, -v153, v157, v8
  v_fma_f32 v9, v152, v157, v101
  v_fma_f32 v157, v153, v156, v9
  v_mov_b32 v156, v8
  s_cmp_lt_u32 9, s36
  s_cbranch_scc0 K2_HD
  v_fma_f32 v8, v152, v156, v102
  v_fma_f32 v8, -v153, v157, v8
  v_fma_f32 v9, v152, v157, v103
  v_fma_f32 v157, v153, v156, v9
  v_mov_b32 v156, v8
  s_cmp_lt_u32 10, s36
  s_cbranch_scc0 K2_HD
  v_fma_f32 v8, v152, v156, v104
  v_fma_f32 v8, -v153, v157, v8
  v_fma_f32 v9, v152, v157, v105
  v_fma_f32 v157, v153, v156, v9
  v_mov_b32 v156, v8
  s_cmp_lt_u32 11, s36
  s_cbranch_scc0 K2_HD
  v_fma_f32 v8, v152, v156, v106
  v_fma_f32 v8, -v153, v157, v8
  v_fma_f32 v9, v152, v157, v107
  v_fma_f32 v157, v153, v156, v9
  v_mov_b32 v156, v8
  s_cmp_lt_u32 12, s36
  s_cbranch_scc0 K2_HD
  v_fma_f32 v8, v152, v156, v108
  v_fma_f32 v8, -v153, v157, v8
  v_fma_f32 v9, v152, v157, v109
  v_fma_f32 v157, v153, v156, v9
  v_mov_b32 v156, v8
  s_cmp_lt_u32 13, s36
  s_cbranch_scc0 K2_HD
  v_fma_f32 v8, v152, v156, v110
  v_fma_f32 v8, -v153, v157, v8
  v_fma_f32 v9, v152, v157, v111
  v_fma_f32 v157, v153, v156, v9
  v_mov_b32 v156, v8
  s_cmp_lt_u32 14, s36
  s_cbranch_scc0 K2_HD
  v_fma_f32 v8, v152, v156, v112
  v_fma_f32 v8, -v153, v157, v8
  v_fma_f32 v9, v152, v157, v113
  v_fma_f32 v157, v153, v156, v9
  v_mov_b32 v156, v8
K2_HD:
  v_mul_f32 v8, v154, v156
  v_fma_f32 v8, -v155, v157, v8
  v_mul_f32 v9, v154, v157
  v_fma_f32 v157, v155, v156, v9
  v_mov_b32 v156, v8
  s_lshl_b32 s47, s36, 7
  s_lshl_b32 s48, s35, 4
  s_add_u32 s47, s47, s48
  s_mul_i32 s47, s47, 5632
  s_add_u32 s47, s47, 8388608
  v_lshlrev_b32 v7, 1, v2
  s_waitcnt vmcnt(0)
  v_mul_f32 v8, v150, v156
  v_fma_f32 v8, -v151, v157, v8
  v_mul_f32 v9, v150, v157
  v_fma_f32 v157, v151, v156, v9
  v_mov_b32 v156, v8
  v_add_f32 v116, v116, v156
  v_add_f32 v132, v132, v157
  v_sub_f32 v132, 0, v132
  v_cvt_pk_bf16_f32 v116, v116, v116
  v_cvt_pk_bf16_f32 v132, v132, v132
  buffer_store_short v116, v7, s[20:23], s47 offen
  buffer_store_short v132, v7, s[20:23], s47 offen offset:1024
  s_add_u32 s47, s47, 5632
  v_mul_f32 v8, v150, v156
  v_fma_f32 v8, -v151, v157, v8
  v_mul_f32 v9, v150, v157
  v_fma_f32 v157, v151, v156, v9
  v_mov_b32 v156, v8
  v_add_f32 v117, v117, v156
  v_add_f32 v133, v133, v157
  v_sub_f32 v133, 0, v133
  v_cvt_pk_bf16_f32 v117, v117, v117
  v_cvt_pk_bf16_f32 v133, v133, v133
  buffer_store_short v117, v7, s[20:23], s47 offen
  buffer_store_short v133, v7, s[20:23], s47 offen offset:1024
  s_add_u32 s47, s47, 5632
  v_mul_f32 v8, v150, v156
  v_fma_f32 v8, -v151, v157, v8
  v_mul_f32 v9, v150, v157
  v_fma_f32 v157, v151, v156, v9
  v_mov_b32 v156, v8
  v_add_f32 v118, v118, v156
  v_add_f32 v134, v134, v157
  v_sub_f32 v134, 0, v134
  v_cvt_pk_bf16_f32 v118, v118, v118
  v_cvt_pk_bf16_f32 v134, v134, v134
  buffer_store_short v118, v7, s[20:23], s47 offen
  buffer_store_short v134, v7, s[20:23], s47 offen offset:1024
  s_add_u32 s47, s47, 5632
  v_mul_f32 v8, v150, v156
  v_fma_f32 v8, -v151, v157, v8
  v_mul_f32 v9, v150, v157
  v_fma_f32 v157, v151, v156, v9
  v_mov_b32 v156, v8
  v_add_f32 v119, v119, v156
  v_add_f32 v135, v135, v157
  v_sub_f32 v135, 0, v135
  v_cvt_pk_bf16_f32 v119, v119, v119
  v_cvt_pk_bf16_f32 v135, v135, v135
  buffer_store_short v119, v7, s[20:23], s47 offen
  buffer_store_short v135, v7, s[20:23], s47 offen offset:1024
  s_add_u32 s47, s47, 5632
  v_mul_f32 v8, v150, v156
  v_fma_f32 v8, -v151, v157, v8
  v_mul_f32 v9, v150, v157
  v_fma_f32 v157, v151, v156, v9
  v_mov_b32 v156, v8
  v_add_f32 v120, v120, v156
  v_add_f32 v136, v136, v157
  v_sub_f32 v136, 0, v136
  v_cvt_pk_bf16_f32 v120, v120, v120
  v_cvt_pk_bf16_f32 v136, v136, v136
  buffer_store_short v120, v7, s[20:23], s47 offen
  buffer_store_short v136, v7, s[20:23], s47 offen offset:1024
  s_add_u32 s47, s47, 5632
  v_mul_f32 v8, v150, v156
  v_fma_f32 v8, -v151, v157, v8
  v_mul_f32 v9, v150, v157
  v_fma_f32 v157, v151, v156, v9
  v_mov_b32 v156, v8
  v_add_f32 v121, v121, v156
  v_add_f32 v137, v137, v157
  v_sub_f32 v137, 0, v137
  v_cvt_pk_bf16_f32 v121, v121, v121
  v_cvt_pk_bf16_f32 v137, v137, v137
  buffer_store_short v121, v7, s[20:23], s47 offen
  buffer_store_short v137, v7, s[20:23], s47 offen offset:1024
  s_add_u32 s47, s47, 5632
  v_mul_f32 v8, v150, v156
  v_fma_f32 v8, -v151, v157, v8
  v_mul_f32 v9, v150, v157
  v_fma_f32 v157, v151, v156, v9
  v_mov_b32 v156, v8
  v_add_f32 v122, v122, v156
  v_add_f32 v138, v138, v157
  v_sub_f32 v138, 0, v138
  v_cvt_pk_bf16_f32 v122, v122, v122
  v_cvt_pk_bf16_f32 v138, v138, v138
  buffer_store_short v122, v7, s[20:23], s47 offen
  buffer_store_short v138, v7, s[20:23], s47 offen offset:1024
  s_add_u32 s47, s47, 5632
  v_mul_f32 v8, v150, v156
  v_fma_f32 v8, -v151, v157, v8
  v_mul_f32 v9, v150, v157
  v_fma_f32 v157, v151, v156, v9
  v_mov_b32 v156, v8
  v_add_f32 v123, v123, v156
  v_add_f32 v139, v139, v157
  v_sub_f32 v139, 0, v139
  v_cvt_pk_bf16_f32 v123, v123, v123
  v_cvt_pk_bf16_f32 v139, v139, v139
  buffer_store_short v123, v7, s[20:23], s47 offen
  buffer_store_short v139, v7, s[20:23], s47 offen offset:1024
  s_add_u32 s47, s47, 5632
  v_mul_f32 v8, v150, v156
  v_fma_f32 v8, -v151, v157, v8
  v_mul_f32 v9, v150, v157
  v_fma_f32 v157, v151, v156, v9
  v_mov_b32 v156, v8
  v_add_f32 v124, v124, v156
  v_add_f32 v140, v140, v157
  v_sub_f32 v140, 0, v140
  v_cvt_pk_bf16_f32 v124, v124, v124
  v_cvt_pk_bf16_f32 v140, v140, v140
  buffer_store_short v124, v7, s[20:23], s47 offen
  buffer_store_short v140, v7, s[20:23], s47 offen offset:1024
  s_add_u32 s47, s47, 5632
  v_mul_f32 v8, v150, v156
  v_fma_f32 v8, -v151, v157, v8
  v_mul_f32 v9, v150, v157
  v_fma_f32 v157, v151, v156, v9
  v_mov_b32 v156, v8
  v_add_f32 v125, v125, v156
  v_add_f32 v141, v141, v157
  v_sub_f32 v141, 0, v141
  v_cvt_pk_bf16_f32 v125, v125, v125
  v_cvt_pk_bf16_f32 v141, v141, v141
  buffer_store_short v125, v7, s[20:23], s47 offen
  buffer_store_short v141, v7, s[20:23], s47 offen offset:1024
  s_add_u32 s47, s47, 5632
  v_mul_f32 v8, v150, v156
  v_fma_f32 v8, -v151, v157, v8
  v_mul_f32 v9, v150, v157
  v_fma_f32 v157, v151, v156, v9
  v_mov_b32 v156, v8
  v_add_f32 v126, v126, v156
  v_add_f32 v142, v142, v157
  v_sub_f32 v142, 0, v142
  v_cvt_pk_bf16_f32 v126, v126, v126
  v_cvt_pk_bf16_f32 v142, v142, v142
  buffer_store_short v126, v7, s[20:23], s47 offen
  buffer_store_short v142, v7, s[20:23], s47 offen offset:1024
  s_add_u32 s47, s47, 5632
  v_mul_f32 v8, v150, v156
  v_fma_f32 v8, -v151, v157, v8
  v_mul_f32 v9, v150, v157
  v_fma_f32 v157, v151, v156, v9
  v_mov_b32 v156, v8
  v_add_f32 v127, v127, v156
  v_add_f32 v143, v143, v157
  v_sub_f32 v143, 0, v143
  v_cvt_pk_bf16_f32 v127, v127, v127
  v_cvt_pk_bf16_f32 v143, v143, v143
  buffer_store_short v127, v7, s[20:23], s47 offen
  buffer_store_short v143, v7, s[20:23], s47 offen offset:1024
  s_add_u32 s47, s47, 5632
  v_mul_f32 v8, v150, v156
  v_fma_f32 v8, -v151, v157, v8
  v_mul_f32 v9, v150, v157
  v_fma_f32 v157, v151, v156, v9
  v_mov_b32 v156, v8
  v_add_f32 v128, v128, v156
  v_add_f32 v144, v144, v157
  v_sub_f32 v144, 0, v144
  v_cvt_pk_bf16_f32 v128, v128, v128
  v_cvt_pk_bf16_f32 v144, v144, v144
  buffer_store_short v128, v7, s[20:23], s47 offen
  buffer_store_short v144, v7, s[20:23], s47 offen offset:1024
  s_add_u32 s47, s47, 5632
  v_mul_f32 v8, v150, v156
  v_fma_f32 v8, -v151, v157, v8
  v_mul_f32 v9, v150, v157
  v_fma_f32 v157, v151, v156, v9
  v_mov_b32 v156, v8
  v_add_f32 v129, v129, v156
  v_add_f32 v145, v145, v157
  v_sub_f32 v145, 0, v145
  v_cvt_pk_bf16_f32 v129, v129, v129
  v_cvt_pk_bf16_f32 v145, v145, v145
  buffer_store_short v129, v7, s[20:23], s47 offen
  buffer_store_short v145, v7, s[20:23], s47 offen offset:1024
  s_add_u32 s47, s47, 5632
  v_mul_f32 v8, v150, v156
  v_fma_f32 v8, -v151, v157, v8
  v_mul_f32 v9, v150, v157
  v_fma_f32 v157, v151, v156, v9
  v_mov_b32 v156, v8
  v_add_f32 v130, v130, v156
  v_add_f32 v146, v146, v157
  v_sub_f32 v146, 0, v146
  v_cvt_pk_bf16_f32 v130, v130, v130
  v_cvt_pk_bf16_f32 v146, v146, v146
  buffer_store_short v130, v7, s[20:23], s47 offen
  buffer_store_short v146, v7, s[20:23], s47 offen offset:1024
  s_add_u32 s47, s47, 5632
  v_mul_f32 v8, v150, v156
  v_fma_f32 v8, -v151, v157, v8
  v_mul_f32 v9, v150, v157
  v_fma_f32 v157, v151, v156, v9
  v_mov_b32 v156, v8
  v_add_f32 v131, v131, v156
  v_add_f32 v147, v147, v157
  v_sub_f32 v147, 0, v147
  v_cvt_pk_bf16_f32 v131, v131, v131
  v_cvt_pk_bf16_f32 v147, v147, v147
  buffer_store_short v131, v7, s[20:23], s47 offen
  buffer_store_short v147, v7, s[20:23], s47 offen offset:1024
  s_add_u32 s47, s47, 5632
K2_END:
  s_endpgm
.p2align 8
.globl k3_kernel
.type k3_kernel,@function
k3_kernel:
  s_cmp_ge_u32 s2, 256
  s_cbranch_scc1 K3_END
  s_load_dwordx2 s[24:25], s[0:1], 40
  s_load_dwordx2 s[26:27], s[0:1], 48
  s_load_dwordx2 s[28:29], s[0:1], 96
  s_load_dwordx2 s[32:33], s[0:1], 136
  v_lshrrev_b32 v1, 6, v0
  s_nop 0
  v_readfirstlane_b32 s34, v1
  s_lshr_b32 s57, s34, 2
  s_and_b32 s34, s34, 3
  s_and_b32 s35, s2, 7
  s_lshl_b32 s35, s35, 2
  s_lshr_b32 s36, s2, 6
  s_add_u32 s35, s35, s36
  s_lshr_b32 s36, s2, 3
  s_and_b32 s36, s36, 7
  s_waitcnt lgkmcnt(0)
  s_mov_b32 s8, s24
  s_and_b32 s9, s25, 0xffff
  s_mov_b32 s10, 524288
  s_mov_b32 s11, 0x00020000
  s_mov_b32 s12, s26
  s_and_b32 s13, s27, 0xffff
  s_mov_b32 s14, 524288
  s_mov_b32 s15, 0x00020000
  s_mov_b32 s16, s28
  s_and_b32 s17, s29, 0xffff
  s_mov_b32 s18, 1835008
  s_mov_b32 s19, 0x00020000
  s_mov_b32 s20, s32
  s_and_b32 s21, s33, 0xffff
  s_mov_b32 s22, 33554432
  s_mov_b32 s23, 0x00020000
  v_and_b32 v1, 63, v0
  v_lshrrev_b32 v4, 4, v1
  v_and_b32 v5, 15, v1
  s_lshl_b32 s47, s34, 2
  v_add_u32 v6, s47, v4
  v_xor_b32 v6, v6, v5
  v_lshlrev_b32 v6, 4, v6
  s_movk_i32 s48, 5632
  v_mul_lo_u32 v7, v4, s48
  v_add_u32 v10, v6, v7
  v_lshl_add_u32 v11, v4, 10, v6
  v_lshrrev_b32 v6, 3, v1
  v_and_b32 v7, 1, v4
  v_lshlrev_b32 v7, 2, v7
  v_and_b32 v8, 7, v1
  v_xor_b32 v7, v7, v8
  v_lshlrev_b32 v7, 4, v7
  v_lshl_add_u32 v12, v6, 10, v7
  s_lshl_b32 s40, s35, 6
  s_add_u32 s40, s40, s47
  s_mul_i32 s40, s40, 5632
  s_add_u32 s40, s40, 8388608
  s_lshl_b32 s41, s36, 6
  s_add_u32 s41, s41, s47
  s_lshl_b32 s41, s41, 10
  s_lshl_b32 s42, s34, 13
  s_lshl_b32 s43, s36, 7
  s_add_u32 s42, s42, s43
  s_lshl_b32 s44, s34, 10
  s_lshl_b32 s45, s34, 10
  s_lshr_b32 s52, s2, 3
  v_and_b32 v5, 31, v1
  v_lshrrev_b32 v6, 5, v1
  s_lshl_b32 s47, s34, 2
  v_add_u32 v6, s47, v6
  v_and_b32 v7, 15, v1
  v_xor_b32 v6, v6, v7
  v_lshlrev_b32 v6, 4, v6
  v_lshl_add_u32 v14, v5, 8, v6
  v_xor_b32 v15, 32, v14
  v_lshrrev_b32 v5, 2, v1
  v_and_b32 v5, 3, v5
  v_and_b32 v6, 3, v1
  v_lshrrev_b32 v7, 1, v4
  v_lshl_add_u32 v7, v7, 3, v5
  s_lshl_b32 s47, s34, 5
  v_add_u32 v7, s47, v7
  v_lshlrev_b32 v7, 7, v7
  v_and_b32 v8, 1, v4
  v_lshlrev_b32 v8, 1, v8
  v_lshrrev_b32 v9, 1, v6
  v_add_u32 v8, v8, v9
  v_lshrrev_b32 v9, 1, v5
  v_lshlrev_b32 v9, 2, v9
  v_xor_b32 v8, v8, v9
  v_lshl_add_u32 v7, v8, 4, v7
  v_and_b32 v9, 1, v6
  v_lshl_add_u32 v16, v9, 3, v7
  v_add_u32 v16, 16384, v16
  v_xor_b32 v17, 64, v16
  v_mov_b32 v128, 0
  v_mov_b32 v129, 0
  v_mov_b32 v130, 0
  v_mov_b32 v131, 0
  v_mov_b32 v132, 0
  v_mov_b32 v133, 0
  v_mov_b32 v134, 0
  v_mov_b32 v135, 0
  v_mov_b32 v136, 0
  v_mov_b32 v137, 0
  v_mov_b32 v138, 0
  v_mov_b32 v139, 0
  v_mov_b32 v140, 0
  v_mov_b32 v141, 0
  v_mov_b32 v142, 0
  v_mov_b32 v143, 0
  v_mov_b32 v144, 0
  v_mov_b32 v145, 0
  v_mov_b32 v146, 0
  v_mov_b32 v147, 0
  v_mov_b32 v148, 0
  v_mov_b32 v149, 0
  v_mov_b32 v150, 0
  v_mov_b32 v151, 0
  v_mov_b32 v152, 0
  v_mov_b32 v153, 0
  v_mov_b32 v154, 0
  v_mov_b32 v155, 0
  v_mov_b32 v156, 0
  v_mov_b32 v157, 0
  v_mov_b32 v158, 0
  v_mov_b32 v159, 0
  v_mov_b32 v160, 0
  v_mov_b32 v161, 0
  v_mov_b32 v162, 0
  v_mov_b32 v163, 0
  v_mov_b32 v164, 0
  v_mov_b32 v165, 0
  v_mov_b32 v166, 0
  v_mov_b32 v167, 0
  v_mov_b32 v168, 0
  v_mov_b32 v169, 0
  v_mov_b32 v170, 0
  v_mov_b32 v171, 0
  v_mov_b32 v172, 0
  v_mov_b32 v173, 0
  v_mov_b32 v174, 0
  v_mov_b32 v175, 0
  v_mov_b32 v176, 0
  v_mov_b32 v177, 0
  v_mov_b32 v178, 0
  v_mov_b32 v179, 0
  v_mov_b32 v180, 0
  v_mov_b32 v181, 0
  v_mov_b32 v182, 0
  v_mov_b32 v183, 0
  v_mov_b32 v184, 0
  v_mov_b32 v185, 0
  v_mov_b32 v186, 0
  v_mov_b32 v187, 0
  v_mov_b32 v188, 0
  v_mov_b32 v189, 0
  v_mov_b32 v190, 0
  v_mov_b32 v191, 0
  v_mov_b32 v192, 0
  v_mov_b32 v193, 0
  v_mov_b32 v194, 0
  v_mov_b32 v195, 0
  v_mov_b32 v196, 0
  v_mov_b32 v197, 0
  v_mov_b32 v198, 0
  v_mov_b32 v199, 0
  v_mov_b32 v200, 0
  v_mov_b32 v201, 0
  v_mov_b32 v202, 0
  v_mov_b32 v203, 0
  v_mov_b32 v204, 0
  v_mov_b32 v205, 0
  v_mov_b32 v206, 0
  v_mov_b32 v207, 0
  v_mov_b32 v208, 0
  v_mov_b32 v209, 0
  v_mov_b32 v210, 0
  v_mov_b32 v211, 0
  v_mov_b32 v212, 0
  v_mov_b32 v213, 0
  v_mov_b32 v214, 0
  v_mov_b32 v215, 0
  v_mov_b32 v216, 0
  v_mov_b32 v217, 0
  v_mov_b32 v218, 0
  v_mov_b32 v219, 0
  v_mov_b32 v220, 0
  v_mov_b32 v221, 0
  v_mov_b32 v222, 0
  v_mov_b32 v223, 0
  v_mov_b32 v224, 0
  v_mov_b32 v225, 0
  v_mov_b32 v226, 0
  v_mov_b32 v227, 0
  v_mov_b32 v228, 0
  v_mov_b32 v229, 0
  v_mov_b32 v230, 0
  v_mov_b32 v231, 0
  v_mov_b32 v232, 0
  v_mov_b32 v233, 0
  v_mov_b32 v234, 0
  v_mov_b32 v235, 0
  v_mov_b32 v236, 0
  v_mov_b32 v237, 0
  v_mov_b32 v238, 0
  v_mov_b32 v239, 0
  v_mov_b32 v240, 0
  v_mov_b32 v241, 0
  v_mov_b32 v242, 0
  v_mov_b32 v243, 0
  v_mov_b32 v244, 0
  v_mov_b32 v245, 0
  v_mov_b32 v246, 0
  v_mov_b32 v247, 0
  v_mov_b32 v248, 0
  v_mov_b32 v249, 0
  v_mov_b32 v250, 0
  v_mov_b32 v251, 0
  v_mov_b32 v252, 0
  v_mov_b32 v253, 0
  v_mov_b32 v254, 0
  v_mov_b32 v255, 0
  s_cmp_eq_u32 s57, 0
  s_cbranch_scc1 K3_COMP
  s_add_u32 s53, s52, 0
  s_and_b32 s53, s53, 3
  s_lshl_b32 s53, s53, 8
  s_add_u32 s54, s53, 0
  s_add_u32 s55, s40, s54
  s_add_u32 s56, s41, s53
  s_add_u32 s47, s55, 0
  s_add_u32 m0, s44, 0
  s_nop 0
  buffer_load_dwordx4 v10, s[20:23], s47 offen lds
  s_add_u32 s47, s55, 90112
  s_add_u32 m0, s44, 4096
  s_nop 0
  buffer_load_dwordx4 v10, s[20:23], s47 offen lds
  s_add_u32 s47, s55, 180224
  s_add_u32 m0, s44, 8192
  s_nop 0
  buffer_load_dwordx4 v10, s[20:23], s47 offen lds
  s_add_u32 s47, s55, 270336
  s_add_u32 m0, s44, 12288
  s_nop 0
  buffer_load_dwordx4 v10, s[20:23], s47 offen lds
  s_add_u32 s47, s56, 0
  s_add_u32 m0, s44, 16384
  s_nop 0
  buffer_load_dwordx4 v11, s[8:11], s47 offen lds
  s_add_u32 s47, s56, 16384
  s_add_u32 m0, s44, 20480
  s_nop 0
  buffer_load_dwordx4 v11, s[8:11], s47 offen lds
  s_add_u32 s47, s56, 32768
  s_add_u32 m0, s44, 24576
  s_nop 0
  buffer_load_dwordx4 v11, s[8:11], s47 offen lds
  s_add_u32 s47, s56, 49152
  s_add_u32 m0, s44, 28672
  s_nop 0
  buffer_load_dwordx4 v11, s[8:11], s47 offen lds
  s_add_u32 s53, s52, 1
  s_and_b32 s53, s53, 3
  s_lshl_b32 s53, s53, 8
  s_add_u32 s54, s53, 0
  s_add_u32 s55, s40, s54
  s_add_u32 s56, s41, s53
  s_add_u32 s47, s55, 0
  s_add_u32 m0, s44, 32768
  s_nop 0
  buffer_load_dwordx4 v10, s[20:23], s47 offen lds
  s_add_u32 s47, s55, 90112
  s_add_u32 m0, s44, 36864
  s_nop 0
  buffer_load_dwordx4 v10, s[20:23], s47 offen lds
  s_add_u32 s47, s55, 180224
  s_add_u32 m0, s44, 40960
  s_nop 0
  buffer_load_dwordx4 v10, s[20:23], s47 offen lds
  s_add_u32 s47, s55, 270336
  s_add_u32 m0, s44, 45056
  s_nop 0
  buffer_load_dwordx4 v10, s[20:23], s47 offen lds
  s_add_u32 s47, s56, 0
  s_add_u32 m0, s44, 49152
  s_nop 0
  buffer_load_dwordx4 v11, s[8:11], s47 offen lds
  s_add_u32 s47, s56, 16384
  s_add_u32 m0, s44, 53248
  s_nop 0
  buffer_load_dwordx4 v11, s[8:11], s47 offen lds
  s_add_u32 s47, s56, 32768
  s_add_u32 m0, s44, 57344
  s_nop 0
  buffer_load_dwordx4 v11, s[8:11], s47 offen lds
  s_add_u32 s47, s56, 49152
  s_add_u32 m0, s44, 61440
  s_nop 0
  buffer_load_dwordx4 v11, s[8:11], s47 offen lds
  s_add_u32 s53, s52, 2
  s_and_b32 s53, s53, 3
  s_lshl_b32 s53, s53, 8
  s_add_u32 s54, s53, 0
  s_add_u32 s55, s40, s54
  s_add_u32 s56, s41, s53
  s_add_u32 s47, s55, 0
  s_add_u32 m0, s44, 65536
  s_nop 0
  buffer_load_dwordx4 v10, s[20:23], s47 offen lds
  s_add_u32 s47, s55, 90112
  s_add_u32 m0, s44, 69632
  s_nop 0
  buffer_load_dwordx4 v10, s[20:23], s47 offen lds
  s_add_u32 s47, s55, 180224
  s_add_u32 m0, s44, 73728
  s_nop 0
  buffer_load_dwordx4 v10, s[20:23], s47 offen lds
  s_add_u32 s47, s55, 270336
  s_add_u32 m0, s44, 77824
  s_nop 0
  buffer_load_dwordx4 v10, s[20:23], s47 offen lds
  s_add_u32 s47, s56, 0
  s_add_u32 m0, s44, 81920
  s_nop 0
  buffer_load_dwordx4 v11, s[8:11], s47 offen lds
  s_add_u32 s47, s56, 16384
  s_add_u32 m0, s44, 86016
  s_nop 0
  buffer_load_dwordx4 v11, s[8:11], s47 offen lds
  s_add_u32 s47, s56, 32768
  s_add_u32 m0, s44, 90112
  s_nop 0
  buffer_load_dwordx4 v11, s[8:11], s47 offen lds
  s_add_u32 s47, s56, 49152
  s_add_u32 m0, s44, 94208
  s_nop 0
  buffer_load_dwordx4 v11, s[8:11], s47 offen lds
  s_add_u32 s53, s52, 3
  s_and_b32 s53, s53, 3
  s_lshl_b32 s53, s53, 8
  s_add_u32 s54, s53, 0
  s_add_u32 s55, s40, s54
  s_add_u32 s56, s41, s53
  s_add_u32 s47, s55, 0
  s_add_u32 m0, s44, 98304
  s_nop 0
  buffer_load_dwordx4 v10, s[20:23], s47 offen lds
  s_add_u32 s47, s55, 90112
  s_add_u32 m0, s44, 102400
  s_nop 0
  buffer_load_dwordx4 v10, s[20:23], s47 offen lds
  s_add_u32 s47, s55, 180224
  s_add_u32 m0, s44, 106496
  s_nop 0
  buffer_load_dwordx4 v10, s[20:23], s47 offen lds
  s_add_u32 s47, s55, 270336
  s_add_u32 m0, s44, 110592
  s_nop 0
  buffer_load_dwordx4 v10, s[20:23], s47 offen lds
  s_add_u32 s47, s56, 0
  s_add_u32 m0, s44, 114688
  s_nop 0
  buffer_load_dwordx4 v11, s[8:11], s47 offen lds
  s_add_u32 s47, s56, 16384
  s_add_u32 m0, s44, 118784
  s_nop 0
  buffer_load_dwordx4 v11, s[8:11], s47 offen lds
  s_add_u32 s47, s56, 32768
  s_add_u32 m0, s44, 122880
  s_nop 0
  buffer_load_dwordx4 v11, s[8:11], s47 offen lds
  s_add_u32 s47, s56, 49152
  s_add_u32 m0, s44, 126976
  s_nop 0
  buffer_load_dwordx4 v11, s[8:11], s47 offen lds
  s_waitcnt vmcnt(24)
  s_barrier
  s_waitcnt vmcnt(16)
  s_barrier
  s_add_u32 s53, s52, 4
  s_and_b32 s53, s53, 3
  s_lshl_b32 s53, s53, 8
  s_add_u32 s54, s53, 1024
  s_add_u32 s55, s40, s54
  s_add_u32 s56, s41, s53
  s_add_u32 s47, s55, 0
  s_add_u32 m0, s44, 131072
  s_nop 0
  buffer_load_dwordx4 v10, s[20:23], s47 offen lds
  s_add_u32 s47, s55, 90112
  s_add_u32 m0, s44, 135168
  s_nop 0
  buffer_load_dwordx4 v10, s[20:23], s47 offen lds
  s_add_u32 s47, s55, 180224
  s_add_u32 m0, s44, 139264
  s_nop 0
  buffer_load_dwordx4 v10, s[20:23], s47 offen lds
  s_add_u32 s47, s55, 270336
  s_add_u32 m0, s44, 143360
  s_nop 0
  buffer_load_dwordx4 v10, s[20:23], s47 offen lds
  s_add_u32 s47, s56, 0
  s_add_u32 m0, s44, 147456
  s_nop 0
  buffer_load_dwordx4 v11, s[12:15], s47 offen lds
  s_add_u32 s47, s56, 16384
  s_add_u32 m0, s44, 151552
  s_nop 0
  buffer_load_dwordx4 v11, s[12:15], s47 offen lds
  s_add_u32 s47, s56, 32768
  s_add_u32 m0, s44, 155648
  s_nop 0
  buffer_load_dwordx4 v11, s[12:15], s47 offen lds
  s_add_u32 s47, s56, 49152
  s_add_u32 m0, s44, 159744
  s_nop 0
  buffer_load_dwordx4 v11, s[12:15], s47 offen lds
  s_waitcnt vmcnt(16)
  s_barrier
  s_add_u32 s53, s52, 5
  s_and_b32 s53, s53, 3
  s_lshl_b32 s53, s53, 8
  s_add_u32 s54, s53, 1024
  s_add_u32 s55, s40, s54
  s_add_u32 s56, s41, s53
  s_add_u32 s47, s55, 0
  s_add_u32 m0, s44, 0
  s_nop 0
  buffer_load_dwordx4 v10, s[20:23], s47 offen lds
  s_add_u32 s47, s55, 90112
  s_add_u32 m0, s44, 4096
  s_nop 0
  buffer_load_dwordx4 v10, s[20:23], s47 offen lds
  s_add_u32 s47, s55, 180224
  s_add_u32 m0, s44, 8192
  s_nop 0
  buffer_load_dwordx4 v10, s[20:23], s47 offen lds
  s_add_u32 s47, s55, 270336
  s_add_u32 m0, s44, 12288
  s_nop 0
  buffer_load_dwordx4 v10, s[20:23], s47 offen lds
  s_add_u32 s47, s56, 0
  s_add_u32 m0, s44, 16384
  s_nop 0
  buffer_load_dwordx4 v11, s[12:15], s47 offen lds
  s_add_u32 s47, s56, 16384
  s_add_u32 m0, s44, 20480
  s_nop 0
  buffer_load_dwordx4 v11, s[12:15], s47 offen lds
  s_add_u32 s47, s56, 32768
  s_add_u32 m0, s44, 24576
  s_nop 0
  buffer_load_dwordx4 v11, s[12:15], s47 offen lds
  s_add_u32 s47, s56, 49152
  s_add_u32 m0, s44, 28672
  s_nop 0
  buffer_load_dwordx4 v11, s[12:15], s47 offen lds
  s_waitcnt vmcnt(16)
  s_barrier
  s_add_u32 s53, s52, 6
  s_and_b32 s53, s53, 3
  s_lshl_b32 s53, s53, 8
  s_add_u32 s54, s53, 1024
  s_add_u32 s55, s40, s54
  s_add_u32 s56, s41, s53
  s_add_u32 s47, s55, 0
  s_add_u32 m0, s44, 32768
  s_nop 0
  buffer_load_dwordx4 v10, s[20:23], s47 offen lds
  s_add_u32 s47, s55, 90112
  s_add_u32 m0, s44, 36864
  s_nop 0
  buffer_load_dwordx4 v10, s[20:23], s47 offen lds
  s_add_u32 s47, s55, 180224
  s_add_u32 m0, s44, 40960
  s_nop 0
  buffer_load_dwordx4 v10, s[20:23], s47 offen lds
  s_add_u32 s47, s55, 270336
  s_add_u32 m0, s44, 45056
  s_nop 0
  buffer_load_dwordx4 v10, s[20:23], s47 offen lds
  s_add_u32 s47, s56, 0
  s_add_u32 m0, s44, 49152
  s_nop 0
  buffer_load_dwordx4 v11, s[12:15], s47 offen lds
  s_add_u32 s47, s56, 16384
  s_add_u32 m0, s44, 53248
  s_nop 0
  buffer_load_dwordx4 v11, s[12:15], s47 offen lds
  s_add_u32 s47, s56, 32768
  s_add_u32 m0, s44, 57344
  s_nop 0
  buffer_load_dwordx4 v11, s[12:15], s47 offen lds
  s_add_u32 s47, s56, 49152
  s_add_u32 m0, s44, 61440
  s_nop 0
  buffer_load_dwordx4 v11, s[12:15], s47 offen lds
  s_waitcnt vmcnt(16)
  s_barrier
  s_add_u32 s53, s52, 7
  s_and_b32 s53, s53, 3
  s_lshl_b32 s53, s53, 8
  s_add_u32 s54, s53, 1024
  s_add_u32 s55, s40, s54
  s_add_u32 s56, s41, s53
  s_add_u32 s47, s55, 0
  s_add_u32 m0, s44, 65536
  s_nop 0
  buffer_load_dwordx4 v10, s[20:23], s47 offen lds
  s_add_u32 s47, s55, 90112
  s_add_u32 m0, s44, 69632
  s_nop 0
  buffer_load_dwordx4 v10, s[20:23], s47 offen lds
  s_add_u32 s47, s55, 180224
  s_add_u32 m0, s44, 73728
  s_nop 0
  buffer_load_dwordx4 v10, s[20:23], s47 offen lds
  s_add_u32 s47, s55, 270336
  s_add_u32 m0, s44, 77824
  s_nop 0
  buffer_load_dwordx4 v10, s[20:23], s47 offen lds
  s_add_u32 s47, s56, 0
  s_add_u32 m0, s44, 81920
  s_nop 0
  buffer_load_dwordx4 v11, s[12:15], s47 offen lds
  s_add_u32 s47, s56, 16384
  s_add_u32 m0, s44, 86016
  s_nop 0
  buffer_load_dwordx4 v11, s[12:15], s47 offen lds
  s_add_u32 s47, s56, 32768
  s_add_u32 m0, s44, 90112
  s_nop 0
  buffer_load_dwordx4 v11, s[12:15], s47 offen lds
  s_add_u32 s47, s56, 49152
  s_add_u32 m0, s44, 94208
  s_nop 0
  buffer_load_dwordx4 v11, s[12:15], s47 offen lds
  s_waitcnt vmcnt(16)
  s_barrier
  s_add_u32 s53, s52, 0
  s_mul_hi_u32 s54, s53, 0x12492493
  s_mul_i32 s54, s54, 14
  s_sub_u32 s53, s53, s54
  s_lshl_b32 s54, s53, 8
  s_add_u32 s54, s54, 2048
  s_lshl_b32 s53, s53, 17
  s_add_u32 s55, s40, s54
  s_add_u32 s56, s42, s53
  s_add_u32 s47, s55, 0
  s_add_u32 m0, s44, 98304
  s_nop 0
  buffer_load_dwordx4 v10, s[20:23], s47 offen lds
  s_add_u32 s47, s55, 90112
  s_add_u32 m0, s44, 102400
  s_nop 0
  buffer_load_dwordx4 v10, s[20:23], s47 offen lds
  s_add_u32 s47, s55, 180224
  s_add_u32 m0, s44, 106496
  s_nop 0
  buffer_load_dwordx4 v10, s[20:23], s47 offen lds
  s_add_u32 s47, s55, 270336
  s_add_u32 m0, s44, 110592
  s_nop 0
  buffer_load_dwordx4 v10, s[20:23], s47 offen lds
  s_add_u32 s47, s56, 0
  s_add_u32 m0, s45, 114688
  s_nop 0
  buffer_load_dwordx4 v12, s[16:19], s47 offen lds
  s_add_u32 s47, s56, 32768
  s_add_u32 m0, s45, 118784
  s_nop 0
  buffer_load_dwordx4 v12, s[16:19], s47 offen lds
  s_add_u32 s47, s56, 65536
  s_add_u32 m0, s45, 122880
  s_nop 0
  buffer_load_dwordx4 v12, s[16:19], s47 offen lds
  s_add_u32 s47, s56, 98304
  s_add_u32 m0, s45, 126976
  s_nop 0
  buffer_load_dwordx4 v12, s[16:19], s47 offen lds
  s_waitcnt vmcnt(16)
  s_barrier
  s_add_u32 s53, s52, 1
  s_mul_hi_u32 s54, s53, 0x12492493
  s_mul_i32 s54, s54, 14
  s_sub_u32 s53, s53, s54
  s_lshl_b32 s54, s53, 8
  s_add_u32 s54, s54, 2048
  s_lshl_b32 s53, s53, 17
  s_add_u32 s55, s40, s54
  s_add_u32 s56, s42, s53
  s_add_u32 s47, s55, 0
  s_add_u32 m0, s44, 131072
  s_nop 0
  buffer_load_dwordx4 v10, s[20:23], s47 offen lds
  s_add_u32 s47, s55, 90112
  s_add_u32 m0, s44, 135168
  s_nop 0
  buffer_load_dwordx4 v10, s[20:23], s47 offen lds
  s_add_u32 s47, s55, 180224
  s_add_u32 m0, s44, 139264
  s_nop 0
  buffer_load_dwordx4 v10, s[20:23], s47 offen lds
  s_add_u32 s47, s55, 270336
  s_add_u32 m0, s44, 143360
  s_nop 0
  buffer_load_dwordx4 v10, s[20:23], s47 offen lds
  s_add_u32 s47, s56, 0
  s_add_u32 m0, s45, 147456
  s_nop 0
  buffer_load_dwordx4 v12, s[16:19], s47 offen lds
  s_add_u32 s47, s56, 32768
  s_add_u32 m0, s45, 151552
  s_nop 0
  buffer_load_dwordx4 v12, s[16:19], s47 offen lds
  s_add_u32 s47, s56, 65536
  s_add_u32 m0, s45, 155648
  s_nop 0
  buffer_load_dwordx4 v12, s[16:19], s47 offen lds
  s_add_u32 s47, s56, 98304
  s_add_u32 m0, s45, 159744
  s_nop 0
  buffer_load_dwordx4 v12, s[16:19], s47 offen lds
  s_waitcnt vmcnt(16)
  s_barrier
  s_add_u32 s53, s52, 2
  s_mul_hi_u32 s54, s53, 0x12492493
  s_mul_i32 s54, s54, 14
  s_sub_u32 s53, s53, s54
  s_lshl_b32 s54, s53, 8
  s_add_u32 s54, s54, 2048
  s_lshl_b32 s53, s53, 17
  s_add_u32 s55, s40, s54
  s_add_u32 s56, s42, s53
  s_add_u32 s47, s55, 0
  s_add_u32 m0, s44, 0
  s_nop 0
  buffer_load_dwordx4 v10, s[20:23], s47 offen lds
  s_add_u32 s47, s55, 90112
  s_add_u32 m0, s44, 4096
  s_nop 0
  buffer_load_dwordx4 v10, s[20:23], s47 offen lds
  s_add_u32 s47, s55, 180224
  s_add_u32 m0, s44, 8192
  s_nop 0
  buffer_load_dwordx4 v10, s[20:23], s47 offen lds
  s_add_u32 s47, s55, 270336
  s_add_u32 m0, s44, 12288
  s_nop 0
  buffer_load_dwordx4 v10, s[20:23], s47 offen lds
  s_add_u32 s47, s56, 0
  s_add_u32 m0, s45, 16384
  s_nop 0
  buffer_load_dwordx4 v12, s[16:19], s47 offen lds
  s_add_u32 s47, s56, 32768
  s_add_u32 m0, s45, 20480
  s_nop 0
  buffer_load_dwordx4 v12, s[16:19], s47 offen lds
  s_add_u32 s47, s56, 65536
  s_add_u32 m0, s45, 24576
  s_nop 0
  buffer_load_dwordx4 v12, s[16:19], s47 offen lds
  s_add_u32 s47, s56, 98304
  s_add_u32 m0, s45, 28672
  s_nop 0
  buffer_load_dwordx4 v12, s[16:19], s47 offen lds
  s_waitcnt vmcnt(16)
  s_barrier
  s_add_u32 s53, s52, 3
  s_mul_hi_u32 s54, s53, 0x12492493
  s_mul_i32 s54, s54, 14
  s_sub_u32 s53, s53, s54
  s_lshl_b32 s54, s53, 8
  s_add_u32 s54, s54, 2048
  s_lshl_b32 s53, s53, 17
  s_add_u32 s55, s40, s54
  s_add_u32 s56, s42, s53
  s_add_u32 s47, s55, 0
  s_add_u32 m0, s44, 32768
  s_nop 0
  buffer_load_dwordx4 v10, s[20:23], s47 offen lds
  s_add_u32 s47, s55, 90112
  s_add_u32 m0, s44, 36864
  s_nop 0
  buffer_load_dwordx4 v10, s[20:23], s47 offen lds
  s_add_u32 s47, s55, 180224
  s_add_u32 m0, s44, 40960
  s_nop 0
  buffer_load_dwordx4 v10, s[20:23], s47 offen lds
  s_add_u32 s47, s55, 270336
  s_add_u32 m0, s44, 45056
  s_nop 0
  buffer_load_dwordx4 v10, s[20:23], s47 offen lds
  s_add_u32 s47, s56, 0
  s_add_u32 m0, s45, 49152
  s_nop 0
  buffer_load_dwordx4 v12, s[16:19], s47 offen lds
  s_add_u32 s47, s56, 32768
  s_add_u32 m0, s45, 53248
  s_nop 0
  buffer_load_dwordx4 v12, s[16:19], s47 offen lds
  s_add_u32 s47, s56, 65536
  s_add_u32 m0, s45, 57344
  s_nop 0
  buffer_load_dwordx4 v12, s[16:19], s47 offen lds
  s_add_u32 s47, s56, 98304
  s_add_u32 m0, s45, 61440
  s_nop 0
  buffer_load_dwordx4 v12, s[16:19], s47 offen lds
  s_waitcnt vmcnt(16)
  s_barrier
  s_add_u32 s53, s52, 4
  s_mul_hi_u32 s54, s53, 0x12492493
  s_mul_i32 s54, s54, 14
  s_sub_u32 s53, s53, s54
  s_lshl_b32 s54, s53, 8
  s_add_u32 s54, s54, 2048
  s_lshl_b32 s53, s53, 17
  s_add_u32 s55, s40, s54
  s_add_u32 s56, s42, s53
  s_add_u32 s47, s55, 0
  s_add_u32 m0, s44, 65536
  s_nop 0
  buffer_load_dwordx4 v10, s[20:23], s47 offen lds
  s_add_u32 s47, s55, 90112
  s_add_u32 m0, s44, 69632
  s_nop 0
  buffer_load_dwordx4 v10, s[20:23], s47 offen lds
  s_add_u32 s47, s55, 180224
  s_add_u32 m0, s44, 73728
  s_nop 0
  buffer_load_dwordx4 v10, s[20:23], s47 offen lds
  s_add_u32 s47, s55, 270336
  s_add_u32 m0, s44, 77824
  s_nop 0
  buffer_load_dwordx4 v10, s[20:23], s47 offen lds
  s_add_u32 s47, s56, 0
  s_add_u32 m0, s45, 81920
  s_nop 0
  buffer_load_dwordx4 v12, s[16:19], s47 offen lds
  s_add_u32 s47, s56, 32768
  s_add_u32 m0, s45, 86016
  s_nop 0
  buffer_load_dwordx4 v12, s[16:19], s47 offen lds
  s_add_u32 s47, s56, 65536
  s_add_u32 m0, s45, 90112
  s_nop 0
  buffer_load_dwordx4 v12, s[16:19], s47 offen lds
  s_add_u32 s47, s56, 98304
  s_add_u32 m0, s45, 94208
  s_nop 0
  buffer_load_dwordx4 v12, s[16:19], s47 offen lds
  s_waitcnt vmcnt(16)
  s_barrier
  s_add_u32 s53, s52, 5
  s_mul_hi_u32 s54, s53, 0x12492493
  s_mul_i32 s54, s54, 14
  s_sub_u32 s53, s53, s54
  s_lshl_b32 s54, s53, 8
  s_add_u32 s54, s54, 2048
  s_lshl_b32 s53, s53, 17
  s_add_u32 s55, s40, s54
  s_add_u32 s56, s42, s53
  s_add_u32 s47, s55, 0
  s_add_u32 m0, s44, 98304
  s_nop 0
  buffer_load_dwordx4 v10, s[20:23], s47 offen lds
  s_add_u32 s47, s55, 90112
  s_add_u32 m0, s44, 102400
  s_nop 0
  buffer_load_dwordx4 v10, s[20:23], s47 offen lds
  s_add_u32 s47, s55, 180224
  s_add_u32 m0, s44, 106496
  s_nop 0
  buffer_load_dwordx4 v10, s[20:23], s47 offen lds
  s_add_u32 s47, s55, 270336
  s_add_u32 m0, s44, 110592
  s_nop 0
  buffer_load_dwordx4 v10, s[20:23], s47 offen lds
  s_add_u32 s47, s56, 0
  s_add_u32 m0, s45, 114688
  s_nop 0
  buffer_load_dwordx4 v12, s[16:19], s47 offen lds
  s_add_u32 s47, s56, 32768
  s_add_u32 m0, s45, 118784
  s_nop 0
  buffer_load_dwordx4 v12, s[16:19], s47 offen lds
  s_add_u32 s47, s56, 65536
  s_add_u32 m0, s45, 122880
  s_nop 0
  buffer_load_dwordx4 v12, s[16:19], s47 offen lds
  s_add_u32 s47, s56, 98304
  s_add_u32 m0, s45, 126976
  s_nop 0
  buffer_load_dwordx4 v12, s[16:19], s47 offen lds
  s_waitcnt vmcnt(16)
  s_barrier
  s_add_u32 s53, s52, 6
  s_mul_hi_u32 s54, s53, 0x12492493
  s_mul_i32 s54, s54, 14
  s_sub_u32 s53, s53, s54
  s_lshl_b32 s54, s53, 8
  s_add_u32 s54, s54, 2048
  s_lshl_b32 s53, s53, 17
  s_add_u32 s55, s40, s54
  s_add_u32 s56, s42, s53
  s_add_u32 s47, s55, 0
  s_add_u32 m0, s44, 131072
  s_nop 0
  buffer_load_dwordx4 v10, s[20:23], s47 offen lds
  s_add_u32 s47, s55, 90112
  s_add_u32 m0, s44, 135168
  s_nop 0
  buffer_load_dwordx4 v10, s[20:23], s47 offen lds
  s_add_u32 s47, s55, 180224
  s_add_u32 m0, s44, 139264
  s_nop 0
  buffer_load_dwordx4 v10, s[20:23], s47 offen lds
  s_add_u32 s47, s55, 270336
  s_add_u32 m0, s44, 143360
  s_nop 0
  buffer_load_dwordx4 v10, s[20:23], s47 offen lds
  s_add_u32 s47, s56, 0
  s_add_u32 m0, s45, 147456
  s_nop 0
  buffer_load_dwordx4 v12, s[16:19], s47 offen lds
  s_add_u32 s47, s56, 32768
  s_add_u32 m0, s45, 151552
  s_nop 0
  buffer_load_dwordx4 v12, s[16:19], s47 offen lds
  s_add_u32 s47, s56, 65536
  s_add_u32 m0, s45, 155648
  s_nop 0
  buffer_load_dwordx4 v12, s[16:19], s47 offen lds
  s_add_u32 s47, s56, 98304
  s_add_u32 m0, s45, 159744
  s_nop 0
  buffer_load_dwordx4 v12, s[16:19], s47 offen lds
  s_waitcnt vmcnt(16)
  s_barrier
  s_add_u32 s53, s52, 7
  s_mul_hi_u32 s54, s53, 0x12492493
  s_mul_i32 s54, s54, 14
  s_sub_u32 s53, s53, s54
  s_lshl_b32 s54, s53, 8
  s_add_u32 s54, s54, 2048
  s_lshl_b32 s53, s53, 17
  s_add_u32 s55, s40, s54
  s_add_u32 s56, s42, s53
  s_add_u32 s47, s55, 0
  s_add_u32 m0, s44, 0
  s_nop 0
  buffer_load_dwordx4 v10, s[20:23], s47 offen lds
  s_add_u32 s47, s55, 90112
  s_add_u32 m0, s44, 4096
  s_nop 0
  buffer_load_dwordx4 v10, s[20:23], s47 offen lds
  s_add_u32 s47, s55, 180224
  s_add_u32 m0, s44, 8192
  s_nop 0
  buffer_load_dwordx4 v10, s[20:23], s47 offen lds
  s_add_u32 s47, s55, 270336
  s_add_u32 m0, s44, 12288
  s_nop 0
  buffer_load_dwordx4 v10, s[20:23], s47 offen lds
  s_add_u32 s47, s56, 0
  s_add_u32 m0, s45, 16384
  s_nop 0
  buffer_load_dwordx4 v12, s[16:19], s47 offen lds
  s_add_u32 s47, s56, 32768
  s_add_u32 m0, s45, 20480
  s_nop 0
  buffer_load_dwordx4 v12, s[16:19], s47 offen lds
  s_add_u32 s47, s56, 65536
  s_add_u32 m0, s45, 24576
  s_nop 0
  buffer_load_dwordx4 v12, s[16:19], s47 offen lds
  s_add_u32 s47, s56, 98304
  s_add_u32 m0, s45, 28672
  s_nop 0
  buffer_load_dwordx4 v12, s[16:19], s47 offen lds
  s_waitcnt vmcnt(16)
  s_barrier
  s_add_u32 s53, s52, 8
  s_mul_hi_u32 s54, s53, 0x12492493
  s_mul_i32 s54, s54, 14
  s_sub_u32 s53, s53, s54
  s_lshl_b32 s54, s53, 8
  s_add_u32 s54, s54, 2048
  s_lshl_b32 s53, s53, 17
  s_add_u32 s55, s40, s54
  s_add_u32 s56, s42, s53
  s_add_u32 s47, s55, 0
  s_add_u32 m0, s44, 32768
  s_nop 0
  buffer_load_dwordx4 v10, s[20:23], s47 offen lds
  s_add_u32 s47, s55, 90112
  s_add_u32 m0, s44, 36864
  s_nop 0
  buffer_load_dwordx4 v10, s[20:23], s47 offen lds
  s_add_u32 s47, s55, 180224
  s_add_u32 m0, s44, 40960
  s_nop 0
  buffer_load_dwordx4 v10, s[20:23], s47 offen lds
  s_add_u32 s47, s55, 270336
  s_add_u32 m0, s44, 45056
  s_nop 0
  buffer_load_dwordx4 v10, s[20:23], s47 offen lds
  s_add_u32 s47, s56, 0
  s_add_u32 m0, s45, 49152
  s_nop 0
  buffer_load_dwordx4 v12, s[16:19], s47 offen lds
  s_add_u32 s47, s56, 32768
  s_add_u32 m0, s45, 53248
  s_nop 0
  buffer_load_dwordx4 v12, s[16:19], s47 offen lds
  s_add_u32 s47, s56, 65536
  s_add_u32 m0, s45, 57344
  s_nop 0
  buffer_load_dwordx4 v12, s[16:19], s47 offen lds
  s_add_u32 s47, s56, 98304
  s_add_u32 m0, s45, 61440
  s_nop 0
  buffer_load_dwordx4 v12, s[16:19], s47 offen lds
  s_waitcnt vmcnt(16)
  s_barrier
  s_add_u32 s53, s52, 9
  s_mul_hi_u32 s54, s53, 0x12492493
  s_mul_i32 s54, s54, 14
  s_sub_u32 s53, s53, s54
  s_lshl_b32 s54, s53, 8
  s_add_u32 s54, s54, 2048
  s_lshl_b32 s53, s53, 17
  s_add_u32 s55, s40, s54
  s_add_u32 s56, s42, s53
  s_add_u32 s47, s55, 0
  s_add_u32 m0, s44, 65536
  s_nop 0
  buffer_load_dwordx4 v10, s[20:23], s47 offen lds
  s_add_u32 s47, s55, 90112
  s_add_u32 m0, s44, 69632
  s_nop 0
  buffer_load_dwordx4 v10, s[20:23], s47 offen lds
  s_add_u32 s47, s55, 180224
  s_add_u32 m0, s44, 73728
  s_nop 0
  buffer_load_dwordx4 v10, s[20:23], s47 offen lds
  s_add_u32 s47, s55, 270336
  s_add_u32 m0, s44, 77824
  s_nop 0
  buffer_load_dwordx4 v10, s[20:23], s47 offen lds
  s_add_u32 s47, s56, 0
  s_add_u32 m0, s45, 81920
  s_nop 0
  buffer_load_dwordx4 v12, s[16:19], s47 offen lds
  s_add_u32 s47, s56, 32768
  s_add_u32 m0, s45, 86016
  s_nop 0
  buffer_load_dwordx4 v12, s[16:19], s47 offen lds
  s_add_u32 s47, s56, 65536
  s_add_u32 m0, s45, 90112
  s_nop 0
  buffer_load_dwordx4 v12, s[16:19], s47 offen lds
  s_add_u32 s47, s56, 98304
  s_add_u32 m0, s45, 94208
  s_nop 0
  buffer_load_dwordx4 v12, s[16:19], s47 offen lds
  s_waitcnt vmcnt(16)
  s_barrier
  s_add_u32 s53, s52, 10
  s_mul_hi_u32 s54, s53, 0x12492493
  s_mul_i32 s54, s54, 14
  s_sub_u32 s53, s53, s54
  s_lshl_b32 s54, s53, 8
  s_add_u32 s54, s54, 2048
  s_lshl_b32 s53, s53, 17
  s_add_u32 s55, s40, s54
  s_add_u32 s56, s42, s53
  s_add_u32 s47, s55, 0
  s_add_u32 m0, s44, 98304
  s_nop 0
  buffer_load_dwordx4 v10, s[20:23], s47 offen lds
  s_add_u32 s47, s55, 90112
  s_add_u32 m0, s44, 102400
  s_nop 0
  buffer_load_dwordx4 v10, s[20:23], s47 offen lds
  s_add_u32 s47, s55, 180224
  s_add_u32 m0, s44, 106496
  s_nop 0
  buffer_load_dwordx4 v10, s[20:23], s47 offen lds
  s_add_u32 s47, s55, 270336
  s_add_u32 m0, s44, 110592
  s_nop 0
  buffer_load_dwordx4 v10, s[20:23], s47 offen lds
  s_add_u32 s47, s56, 0
  s_add_u32 m0, s45, 114688
  s_nop 0
  buffer_load_dwordx4 v12, s[16:19], s47 offen lds
  s_add_u32 s47, s56, 32768
  s_add_u32 m0, s45, 118784
  s_nop 0
  buffer_load_dwordx4 v12, s[16:19], s47 offen lds
  s_add_u32 s47, s56, 65536
  s_add_u32 m0, s45, 122880
  s_nop 0
  buffer_load_dwordx4 v12, s[16:19], s47 offen lds
  s_add_u32 s47, s56, 98304
  s_add_u32 m0, s45, 126976
  s_nop 0
  buffer_load_dwordx4 v12, s[16:19], s47 offen lds
  s_waitcnt vmcnt(16)
  s_barrier
  s_add_u32 s53, s52, 11
  s_mul_hi_u32 s54, s53, 0x12492493
  s_mul_i32 s54, s54, 14
  s_sub_u32 s53, s53, s54
  s_lshl_b32 s54, s53, 8
  s_add_u32 s54, s54, 2048
  s_lshl_b32 s53, s53, 17
  s_add_u32 s55, s40, s54
  s_add_u32 s56, s42, s53
  s_add_u32 s47, s55, 0
  s_add_u32 m0, s44, 131072
  s_nop 0
  buffer_load_dwordx4 v10, s[20:23], s47 offen lds
  s_add_u32 s47, s55, 90112
  s_add_u32 m0, s44, 135168
  s_nop 0
  buffer_load_dwordx4 v10, s[20:23], s47 offen lds
  s_add_u32 s47, s55, 180224
  s_add_u32 m0, s44, 139264
  s_nop 0
  buffer_load_dwordx4 v10, s[20:23], s47 offen lds
  s_add_u32 s47, s55, 270336
  s_add_u32 m0, s44, 143360
  s_nop 0
  buffer_load_dwordx4 v10, s[20:23], s47 offen lds
  s_add_u32 s47, s56, 0
  s_add_u32 m0, s45, 147456
  s_nop 0
  buffer_load_dwordx4 v12, s[16:19], s47 offen lds
  s_add_u32 s47, s56, 32768
  s_add_u32 m0, s45, 151552
  s_nop 0
  buffer_load_dwordx4 v12, s[16:19], s47 offen lds
  s_add_u32 s47, s56, 65536
  s_add_u32 m0, s45, 155648
  s_nop 0
  buffer_load_dwordx4 v12, s[16:19], s47 offen lds
  s_add_u32 s47, s56, 98304
  s_add_u32 m0, s45, 159744
  s_nop 0
  buffer_load_dwordx4 v12, s[16:19], s47 offen lds
  s_waitcnt vmcnt(16)
  s_barrier
  s_add_u32 s53, s52, 12
  s_mul_hi_u32 s54, s53, 0x12492493
  s_mul_i32 s54, s54, 14
  s_sub_u32 s53, s53, s54
  s_lshl_b32 s54, s53, 8
  s_add_u32 s54, s54, 2048
  s_lshl_b32 s53, s53, 17
  s_add_u32 s55, s40, s54
  s_add_u32 s56, s42, s53
  s_add_u32 s47, s55, 0
  s_add_u32 m0, s44, 0
  s_nop 0
  buffer_load_dwordx4 v10, s[20:23], s47 offen lds
  s_add_u32 s47, s55, 90112
  s_add_u32 m0, s44, 4096
  s_nop 0
  buffer_load_dwordx4 v10, s[20:23], s47 offen lds
  s_add_u32 s47, s55, 180224
  s_add_u32 m0, s44, 8192
  s_nop 0
  buffer_load_dwordx4 v10, s[20:23], s47 offen lds
  s_add_u32 s47, s55, 270336
  s_add_u32 m0, s44, 12288
  s_nop 0
  buffer_load_dwordx4 v10, s[20:23], s47 offen lds
  s_add_u32 s47, s56, 0
  s_add_u32 m0, s45, 16384
  s_nop 0
  buffer_load_dwordx4 v12, s[16:19], s47 offen lds
  s_add_u32 s47, s56, 32768
  s_add_u32 m0, s45, 20480
  s_nop 0
  buffer_load_dwordx4 v12, s[16:19], s47 offen lds
  s_add_u32 s47, s56, 65536
  s_add_u32 m0, s45, 24576
  s_nop 0
  buffer_load_dwordx4 v12, s[16:19], s47 offen lds
  s_add_u32 s47, s56, 98304
  s_add_u32 m0, s45, 28672
  s_nop 0
  buffer_load_dwordx4 v12, s[16:19], s47 offen lds
  s_waitcnt vmcnt(16)
  s_barrier
  s_add_u32 s53, s52, 13
  s_mul_hi_u32 s54, s53, 0x12492493
  s_mul_i32 s54, s54, 14
  s_sub_u32 s53, s53, s54
  s_lshl_b32 s54, s53, 8
  s_add_u32 s54, s54, 2048
  s_lshl_b32 s53, s53, 17
  s_add_u32 s55, s40, s54
  s_add_u32 s56, s42, s53
  s_add_u32 s47, s55, 0
  s_add_u32 m0, s44, 32768
  s_nop 0
  buffer_load_dwordx4 v10, s[20:23], s47 offen lds
  s_add_u32 s47, s55, 90112
  s_add_u32 m0, s44, 36864
  s_nop 0
  buffer_load_dwordx4 v10, s[20:23], s47 offen lds
  s_add_u32 s47, s55, 180224
  s_add_u32 m0, s44, 40960
  s_nop 0
  buffer_load_dwordx4 v10, s[20:23], s47 offen lds
  s_add_u32 s47, s55, 270336
  s_add_u32 m0, s44, 45056
  s_nop 0
  buffer_load_dwordx4 v10, s[20:23], s47 offen lds
  s_add_u32 s47, s56, 0
  s_add_u32 m0, s45, 49152
  s_nop 0
  buffer_load_dwordx4 v12, s[16:19], s47 offen lds
  s_add_u32 s47, s56, 32768
  s_add_u32 m0, s45, 53248
  s_nop 0
  buffer_load_dwordx4 v12, s[16:19], s47 offen lds
  s_add_u32 s47, s56, 65536
  s_add_u32 m0, s45, 57344
  s_nop 0
  buffer_load_dwordx4 v12, s[16:19], s47 offen lds
  s_add_u32 s47, s56, 98304
  s_add_u32 m0, s45, 61440
  s_nop 0
  buffer_load_dwordx4 v12, s[16:19], s47 offen lds
  s_waitcnt vmcnt(16)
  s_barrier
  s_waitcnt vmcnt(8)
  s_barrier
  s_waitcnt vmcnt(0)
  s_barrier
  s_endpgm
K3_COMP:
  s_load_dwordx2 s[24:25], s[0:1], 0
  s_load_dwordx2 s[26:27], s[0:1], 64
  s_load_dwordx2 s[28:29], s[0:1], 104
  s_load_dwordx2 s[30:31], s[0:1], 120
  s_waitcnt lgkmcnt(0)
  s_mov_b32 s4, s24
  s_and_b32 s5, s25, 0xffff
  s_mov_b32 s6, 2097152
  s_mov_b32 s7, 0x00020000
  s_mov_b32 s8, s26
  s_and_b32 s9, s27, 0xffff
  s_mov_b32 s10, 1024
  s_mov_b32 s11, 0x00020000
  s_mov_b32 s12, s28
  s_and_b32 s13, s29, 0xffff
  s_mov_b32 s14, 1024
  s_mov_b32 s15, 0x00020000
  s_mov_b32 s16, s30
  s_and_b32 s17, s31, 0xffff
  s_mov_b32 s18, 4194304
  s_mov_b32 s19, 0x00020000
  v_lshrrev_b32 v2, 2, v0
  v_and_b32 v3, 3, v0
  v_lshlrev_b32 v5, 5, v3
  v_lshl_add_u32 v6, v2, 10, v5
  s_lshl_b32 s47, s35, 16
  s_lshl_b32 s48, s36, 7
  s_add_u32 s47, s47, s48
  buffer_load_dwordx4 v[96:99], v6, s[4:7], s47 offen
  buffer_load_dwordx4 v[100:103], v6, s[4:7], s47 offen offset:16
  buffer_load_dwordx4 v[104:107], v5, s[8:11], s48 offen
  buffer_load_dwordx4 v[108:111], v5, s[8:11], s48 offen offset:16
  buffer_load_dwordx4 v[112:115], v5, s[12:15], s48 offen
  buffer_load_dwordx4 v[116:119], v5, s[12:15], s48 offen offset:16
  v_lshlrev_b32 v7, 2, v2
  s_lshl_b32 s49, s35, 8
  s_add_u32 s49, s49, 25231360
  buffer_load_dword v120, v7, s[20:23], s49 offen
  s_barrier
  ds_read_b128 v[32:35], v14 offset:0
  ds_read_b128 v[36:39], v14 offset:8192
  ds_read_b128 v[40:43], v14 offset:16384
  ds_read_b128 v[44:47], v14 offset:24576
  ds_read_b128 v[48:51], v15 offset:0
  ds_read_b128 v[52:55], v15 offset:8192
  ds_read_b128 v[56:59], v15 offset:16384
  ds_read_b128 v[60:63], v15 offset:24576
  s_waitcnt lgkmcnt(0)
  s_barrier
  v_add_u32 v14, 32768, v14
  v_add_u32 v15, 32768, v15
  v_add_u32 v16, 32768, v16
  v_add_u32 v17, 32768, v17
  ds_read_b128 v[64:67], v14 offset:0
  ds_read_b128 v[68:71], v14 offset:8192
  ds_read_b128 v[72:75], v14 offset:16384
  ds_read_b128 v[76:79], v14 offset:24576
  ds_read_b128 v[80:83], v15 offset:0
  ds_read_b128 v[84:87], v15 offset:8192
  ds_read_b128 v[88:91], v15 offset:16384
  ds_read_b128 v[92:95], v15 offset:24576
  v_mfma_f32_32x32x16_bf16 v[128:143], v[32:35], v[40:43], v[128:143]
  v_mfma_f32_32x32x16_bf16 v[144:159], v[32:35], v[44:47], v[144:159]
  v_mfma_f32_32x32x16_bf16 v[160:175], v[36:39], v[40:43], v[160:175]
  v_mfma_f32_32x32x16_bf16 v[176:191], v[36:39], v[44:47], v[176:191]
  v_mfma_f32_32x32x16_bf16 v[128:143], v[48:51], v[56:59], v[128:143]
  v_mfma_f32_32x32x16_bf16 v[144:159], v[48:51], v[60:63], v[144:159]
  v_mfma_f32_32x32x16_bf16 v[160:175], v[52:55], v[56:59], v[160:175]
  v_mfma_f32_32x32x16_bf16 v[176:191], v[52:55], v[60:63], v[176:191]
  s_waitcnt lgkmcnt(0)
  s_barrier
  v_add_u32 v14, 32768, v14
  v_add_u32 v15, 32768, v15
  v_add_u32 v16, 32768, v16
  v_add_u32 v17, 32768, v17
  ds_read_b128 v[32:35], v14 offset:0
  ds_read_b128 v[36:39], v14 offset:8192
  ds_read_b128 v[40:43], v14 offset:16384
  ds_read_b128 v[44:47], v14 offset:24576
  ds_read_b128 v[48:51], v15 offset:0
  ds_read_b128 v[52:55], v15 offset:8192
  ds_read_b128 v[56:59], v15 offset:16384
  ds_read_b128 v[60:63], v15 offset:24576
  v_mfma_f32_32x32x16_bf16 v[128:143], v[64:67], v[72:75], v[128:143]
  v_mfma_f32_32x32x16_bf16 v[144:159], v[64:67], v[76:79], v[144:159]
  v_mfma_f32_32x32x16_bf16 v[160:175], v[68:71], v[72:75], v[160:175]
  v_mfma_f32_32x32x16_bf16 v[176:191], v[68:71], v[76:79], v[176:191]
  v_mfma_f32_32x32x16_bf16 v[128:143], v[80:83], v[88:91], v[128:143]
  v_mfma_f32_32x32x16_bf16 v[144:159], v[80:83], v[92:95], v[144:159]
  v_mfma_f32_32x32x16_bf16 v[160:175], v[84:87], v[88:91], v[160:175]
  v_mfma_f32_32x32x16_bf16 v[176:191], v[84:87], v[92:95], v[176:191]
  s_waitcnt lgkmcnt(0)
  s_barrier
  v_add_u32 v14, 32768, v14
  v_add_u32 v15, 32768, v15
  v_add_u32 v16, 32768, v16
  v_add_u32 v17, 32768, v17
  ds_read_b128 v[64:67], v14 offset:0
  ds_read_b128 v[68:71], v14 offset:8192
  ds_read_b128 v[72:75], v14 offset:16384
  ds_read_b128 v[76:79], v14 offset:24576
  ds_read_b128 v[80:83], v15 offset:0
  ds_read_b128 v[84:87], v15 offset:8192
  ds_read_b128 v[88:91], v15 offset:16384
  ds_read_b128 v[92:95], v15 offset:24576
  v_mfma_f32_32x32x16_bf16 v[128:143], v[32:35], v[40:43], v[128:143]
  v_mfma_f32_32x32x16_bf16 v[144:159], v[32:35], v[44:47], v[144:159]
  v_mfma_f32_32x32x16_bf16 v[160:175], v[36:39], v[40:43], v[160:175]
  v_mfma_f32_32x32x16_bf16 v[176:191], v[36:39], v[44:47], v[176:191]
  v_mfma_f32_32x32x16_bf16 v[128:143], v[48:51], v[56:59], v[128:143]
  v_mfma_f32_32x32x16_bf16 v[144:159], v[48:51], v[60:63], v[144:159]
  v_mfma_f32_32x32x16_bf16 v[160:175], v[52:55], v[56:59], v[160:175]
  v_mfma_f32_32x32x16_bf16 v[176:191], v[52:55], v[60:63], v[176:191]
  s_waitcnt lgkmcnt(0)
  s_barrier
  v_add_u32 v14, 32768, v14
  v_add_u32 v15, 32768, v15
  v_add_u32 v16, 32768, v16
  v_add_u32 v17, 32768, v17
  ds_read_b128 v[32:35], v14 offset:0
  ds_read_b128 v[36:39], v14 offset:8192
  ds_read_b128 v[40:43], v14 offset:16384
  ds_read_b128 v[44:47], v14 offset:24576
  ds_read_b128 v[48:51], v15 offset:0
  ds_read_b128 v[52:55], v15 offset:8192
  ds_read_b128 v[56:59], v15 offset:16384
  ds_read_b128 v[60:63], v15 offset:24576
  v_mfma_f32_32x32x16_bf16 v[128:143], v[64:67], v[72:75], v[128:143]
  v_mfma_f32_32x32x16_bf16 v[144:159], v[64:67], v[76:79], v[144:159]
  v_mfma_f32_32x32x16_bf16 v[160:175], v[68:71], v[72:75], v[160:175]
  v_mfma_f32_32x32x16_bf16 v[176:191], v[68:71], v[76:79], v[176:191]
  v_mfma_f32_32x32x16_bf16 v[128:143], v[80:83], v[88:91], v[128:143]
  v_mfma_f32_32x32x16_bf16 v[144:159], v[80:83], v[92:95], v[144:159]
  v_mfma_f32_32x32x16_bf16 v[160:175], v[84:87], v[88:91], v[160:175]
  v_mfma_f32_32x32x16_bf16 v[176:191], v[84:87], v[92:95], v[176:191]
  s_waitcnt lgkmcnt(0)
  s_barrier
  v_add_u32 v14, -131072, v14
  v_add_u32 v15, -131072, v15
  v_add_u32 v16, -131072, v16
  v_add_u32 v17, -131072, v17
  ds_read_b128 v[64:67], v14 offset:0
  ds_read_b128 v[68:71], v14 offset:8192
  ds_read_b128 v[72:75], v14 offset:16384
  ds_read_b128 v[76:79], v14 offset:24576
  ds_read_b128 v[80:83], v15 offset:0
  ds_read_b128 v[84:87], v15 offset:8192
  ds_read_b128 v[88:91], v15 offset:16384
  ds_read_b128 v[92:95], v15 offset:24576
  v_mfma_f32_32x32x16_bf16 v[128:143], v[32:35], v[40:43], v[128:143]
  v_mfma_f32_32x32x16_bf16 v[144:159], v[32:35], v[44:47], v[144:159]
  v_mfma_f32_32x32x16_bf16 v[160:175], v[36:39], v[40:43], v[160:175]
  v_mfma_f32_32x32x16_bf16 v[176:191], v[36:39], v[44:47], v[176:191]
  v_mfma_f32_32x32x16_bf16 v[128:143], v[48:51], v[56:59], v[128:143]
  v_mfma_f32_32x32x16_bf16 v[144:159], v[48:51], v[60:63], v[144:159]
  v_mfma_f32_32x32x16_bf16 v[160:175], v[52:55], v[56:59], v[160:175]
  v_mfma_f32_32x32x16_bf16 v[176:191], v[52:55], v[60:63], v[176:191]
  s_waitcnt lgkmcnt(0)
  s_barrier
  v_add_u32 v14, 32768, v14
  v_add_u32 v15, 32768, v15
  v_add_u32 v16, 32768, v16
  v_add_u32 v17, 32768, v17
  ds_read_b128 v[32:35], v14 offset:0
  ds_read_b128 v[36:39], v14 offset:8192
  ds_read_b128 v[40:43], v14 offset:16384
  ds_read_b128 v[44:47], v14 offset:24576
  ds_read_b128 v[48:51], v15 offset:0
  ds_read_b128 v[52:55], v15 offset:8192
  ds_read_b128 v[56:59], v15 offset:16384
  ds_read_b128 v[60:63], v15 offset:24576
  v_mfma_f32_32x32x16_bf16 v[128:143], v[64:67], v[72:75], v[128:143]
  v_mfma_f32_32x32x16_bf16 v[144:159], v[64:67], v[76:79], v[144:159]
  v_mfma_f32_32x32x16_bf16 v[160:175], v[68:71], v[72:75], v[160:175]
  v_mfma_f32_32x32x16_bf16 v[176:191], v[68:71], v[76:79], v[176:191]
  v_mfma_f32_32x32x16_bf16 v[128:143], v[80:83], v[88:91], v[128:143]
  v_mfma_f32_32x32x16_bf16 v[144:159], v[80:83], v[92:95], v[144:159]
  v_mfma_f32_32x32x16_bf16 v[160:175], v[84:87], v[88:91], v[160:175]
  v_mfma_f32_32x32x16_bf16 v[176:191], v[84:87], v[92:95], v[176:191]
  s_waitcnt lgkmcnt(0)
  s_barrier
  v_add_u32 v14, 32768, v14
  v_add_u32 v15, 32768, v15
  v_add_u32 v16, 32768, v16
  v_add_u32 v17, 32768, v17
  ds_read_b128 v[64:67], v14 offset:0
  ds_read_b128 v[68:71], v14 offset:8192
  ds_read_b128 v[72:75], v14 offset:16384
  ds_read_b128 v[76:79], v14 offset:24576
  ds_read_b128 v[80:83], v15 offset:0
  ds_read_b128 v[84:87], v15 offset:8192
  ds_read_b128 v[88:91], v15 offset:16384
  ds_read_b128 v[92:95], v15 offset:24576
  v_mfma_f32_32x32x16_bf16 v[128:143], v[32:35], v[40:43], v[128:143]
  v_mfma_f32_32x32x16_bf16 v[144:159], v[32:35], v[44:47], v[144:159]
  v_mfma_f32_32x32x16_bf16 v[160:175], v[36:39], v[40:43], v[160:175]
  v_mfma_f32_32x32x16_bf16 v[176:191], v[36:39], v[44:47], v[176:191]
  v_mfma_f32_32x32x16_bf16 v[128:143], v[48:51], v[56:59], v[128:143]
  v_mfma_f32_32x32x16_bf16 v[144:159], v[48:51], v[60:63], v[144:159]
  v_mfma_f32_32x32x16_bf16 v[160:175], v[52:55], v[56:59], v[160:175]
  v_mfma_f32_32x32x16_bf16 v[176:191], v[52:55], v[60:63], v[176:191]
  s_waitcnt lgkmcnt(0)
  s_barrier
  v_add_u32 v14, 32768, v14
  v_add_u32 v15, 32768, v15
  v_add_u32 v16, 32768, v16
  v_add_u32 v17, 32768, v17
  ds_read_b128 v[32:35], v14 offset:0
  ds_read_b128 v[36:39], v14 offset:8192
  ds_read_b64_tr_b16 v[40:41], v16 offset:0
  ds_read_b64_tr_b16 v[42:43], v16 offset:512
  ds_read_b64_tr_b16 v[44:45], v17 offset:0
  ds_read_b64_tr_b16 v[46:47], v17 offset:512
  ds_read_b128 v[48:51], v15 offset:0
  ds_read_b128 v[52:55], v15 offset:8192
  ds_read_b64_tr_b16 v[56:57], v16 offset:2048
  ds_read_b64_tr_b16 v[58:59], v16 offset:2560
  ds_read_b64_tr_b16 v[60:61], v17 offset:2048
  ds_read_b64_tr_b16 v[62:63], v17 offset:2560
  v_mfma_f32_32x32x16_bf16 v[128:143], v[64:67], v[72:75], v[128:143]
  v_mfma_f32_32x32x16_bf16 v[144:159], v[64:67], v[76:79], v[144:159]
  v_mfma_f32_32x32x16_bf16 v[160:175], v[68:71], v[72:75], v[160:175]
  v_mfma_f32_32x32x16_bf16 v[176:191], v[68:71], v[76:79], v[176:191]
  v_mfma_f32_32x32x16_bf16 v[128:143], v[80:83], v[88:91], v[128:143]
  v_mfma_f32_32x32x16_bf16 v[144:159], v[80:83], v[92:95], v[144:159]
  v_mfma_f32_32x32x16_bf16 v[160:175], v[84:87], v[88:91], v[160:175]
  v_mfma_f32_32x32x16_bf16 v[176:191], v[84:87], v[92:95], v[176:191]
  s_waitcnt lgkmcnt(0)
  s_barrier
  v_add_u32 v14, 32768, v14
  v_add_u32 v15, 32768, v15
  v_add_u32 v16, 32768, v16
  v_add_u32 v17, 32768, v17
  ds_read_b128 v[64:67], v14 offset:0
  ds_read_b128 v[68:71], v14 offset:8192
  ds_read_b64_tr_b16 v[72:73], v16 offset:0
  ds_read_b64_tr_b16 v[74:75], v16 offset:512
  ds_read_b64_tr_b16 v[76:77], v17 offset:0
  ds_read_b64_tr_b16 v[78:79], v17 offset:512
  ds_read_b128 v[80:83], v15 offset:0
  ds_read_b128 v[84:87], v15 offset:8192
  ds_read_b64_tr_b16 v[88:89], v16 offset:2048
  ds_read_b64_tr_b16 v[90:91], v16 offset:2560
  ds_read_b64_tr_b16 v[92:93], v17 offset:2048
  ds_read_b64_tr_b16 v[94:95], v17 offset:2560
  v_mfma_f32_32x32x16_bf16 v[192:207], v[32:35], v[40:43], v[192:207]
  v_mfma_f32_32x32x16_bf16 v[208:223], v[32:35], v[44:47], v[208:223]
  v_mfma_f32_32x32x16_bf16 v[224:239], v[36:39], v[40:43], v[224:239]
  v_mfma_f32_32x32x16_bf16 v[240:255], v[36:39], v[44:47], v[240:255]
  v_mfma_f32_32x32x16_bf16 v[192:207], v[48:51], v[56:59], v[192:207]
  v_mfma_f32_32x32x16_bf16 v[208:223], v[48:51], v[60:63], v[208:223]
  v_mfma_f32_32x32x16_bf16 v[224:239], v[52:55], v[56:59], v[224:239]
  v_mfma_f32_32x32x16_bf16 v[240:255], v[52:55], v[60:63], v[240:255]
  s_waitcnt lgkmcnt(0)
  s_barrier
  v_add_u32 v14, -131072, v14
  v_add_u32 v15, -131072, v15
  v_add_u32 v16, -131072, v16
  v_add_u32 v17, -131072, v17
  ds_read_b128 v[32:35], v14 offset:0
  ds_read_b128 v[36:39], v14 offset:8192
  ds_read_b64_tr_b16 v[40:41], v16 offset:0
  ds_read_b64_tr_b16 v[42:43], v16 offset:512
  ds_read_b64_tr_b16 v[44:45], v17 offset:0
  ds_read_b64_tr_b16 v[46:47], v17 offset:512
  ds_read_b128 v[48:51], v15 offset:0
  ds_read_b128 v[52:55], v15 offset:8192
  ds_read_b64_tr_b16 v[56:57], v16 offset:2048
  ds_read_b64_tr_b16 v[58:59], v16 offset:2560
  ds_read_b64_tr_b16 v[60:61], v17 offset:2048
  ds_read_b64_tr_b16 v[62:63], v17 offset:2560
  v_mfma_f32_32x32x16_bf16 v[192:207], v[64:67], v[72:75], v[192:207]
  v_mfma_f32_32x32x16_bf16 v[208:223], v[64:67], v[76:79], v[208:223]
  v_mfma_f32_32x32x16_bf16 v[224:239], v[68:71], v[72:75], v[224:239]
  v_mfma_f32_32x32x16_bf16 v[240:255], v[68:71], v[76:79], v[240:255]
  v_mfma_f32_32x32x16_bf16 v[192:207], v[80:83], v[88:91], v[192:207]
  v_mfma_f32_32x32x16_bf16 v[208:223], v[80:83], v[92:95], v[208:223]
  v_mfma_f32_32x32x16_bf16 v[224:239], v[84:87], v[88:91], v[224:239]
  v_mfma_f32_32x32x16_bf16 v[240:255], v[84:87], v[92:95], v[240:255]
  s_waitcnt lgkmcnt(0)
  s_barrier
  v_add_u32 v14, 32768, v14
  v_add_u32 v15, 32768, v15
  v_add_u32 v16, 32768, v16
  v_add_u32 v17, 32768, v17
  ds_read_b128 v[64:67], v14 offset:0
  ds_read_b128 v[68:71], v14 offset:8192
  ds_read_b64_tr_b16 v[72:73], v16 offset:0
  ds_read_b64_tr_b16 v[74:75], v16 offset:512
  ds_read_b64_tr_b16 v[76:77], v17 offset:0
  ds_read_b64_tr_b16 v[78:79], v17 offset:512
  ds_read_b128 v[80:83], v15 offset:0
  ds_read_b128 v[84:87], v15 offset:8192
  ds_read_b64_tr_b16 v[88:89], v16 offset:2048
  ds_read_b64_tr_b16 v[90:91], v16 offset:2560
  ds_read_b64_tr_b16 v[92:93], v17 offset:2048
  ds_read_b64_tr_b16 v[94:95], v17 offset:2560
  v_mfma_f32_32x32x16_bf16 v[192:207], v[32:35], v[40:43], v[192:207]
  v_mfma_f32_32x32x16_bf16 v[208:223], v[32:35], v[44:47], v[208:223]
  v_mfma_f32_32x32x16_bf16 v[224:239], v[36:39], v[40:43], v[224:239]
  v_mfma_f32_32x32x16_bf16 v[240:255], v[36:39], v[44:47], v[240:255]
  v_mfma_f32_32x32x16_bf16 v[192:207], v[48:51], v[56:59], v[192:207]
  v_mfma_f32_32x32x16_bf16 v[208:223], v[48:51], v[60:63], v[208:223]
  v_mfma_f32_32x32x16_bf16 v[224:239], v[52:55], v[56:59], v[224:239]
  v_mfma_f32_32x32x16_bf16 v[240:255], v[52:55], v[60:63], v[240:255]
  s_waitcnt lgkmcnt(0)
  s_barrier
  v_add_u32 v14, 32768, v14
  v_add_u32 v15, 32768, v15
  v_add_u32 v16, 32768, v16
  v_add_u32 v17, 32768, v17
  ds_read_b128 v[32:35], v14 offset:0
  ds_read_b128 v[36:39], v14 offset:8192
  ds_read_b64_tr_b16 v[40:41], v16 offset:0
  ds_read_b64_tr_b16 v[42:43], v16 offset:512
  ds_read_b64_tr_b16 v[44:45], v17 offset:0
  ds_read_b64_tr_b16 v[46:47], v17 offset:512
  ds_read_b128 v[48:51], v15 offset:0
  ds_read_b128 v[52:55], v15 offset:8192
  ds_read_b64_tr_b16 v[56:57], v16 offset:2048
  ds_read_b64_tr_b16 v[58:59], v16 offset:2560
  ds_read_b64_tr_b16 v[60:61], v17 offset:2048
  ds_read_b64_tr_b16 v[62:63], v17 offset:2560
  v_mfma_f32_32x32x16_bf16 v[192:207], v[64:67], v[72:75], v[192:207]
  v_mfma_f32_32x32x16_bf16 v[208:223], v[64:67], v[76:79], v[208:223]
  v_mfma_f32_32x32x16_bf16 v[224:239], v[68:71], v[72:75], v[224:239]
  v_mfma_f32_32x32x16_bf16 v[240:255], v[68:71], v[76:79], v[240:255]
  v_mfma_f32_32x32x16_bf16 v[192:207], v[80:83], v[88:91], v[192:207]
  v_mfma_f32_32x32x16_bf16 v[208:223], v[80:83], v[92:95], v[208:223]
  v_mfma_f32_32x32x16_bf16 v[224:239], v[84:87], v[88:91], v[224:239]
  v_mfma_f32_32x32x16_bf16 v[240:255], v[84:87], v[92:95], v[240:255]
  s_waitcnt lgkmcnt(0)
  s_barrier
  v_add_u32 v14, 32768, v14
  v_add_u32 v15, 32768, v15
  v_add_u32 v16, 32768, v16
  v_add_u32 v17, 32768, v17
  ds_read_b128 v[64:67], v14 offset:0
  ds_read_b128 v[68:71], v14 offset:8192
  ds_read_b64_tr_b16 v[72:73], v16 offset:0
  ds_read_b64_tr_b16 v[74:75], v16 offset:512
  ds_read_b64_tr_b16 v[76:77], v17 offset:0
  ds_read_b64_tr_b16 v[78:79], v17 offset:512
  ds_read_b128 v[80:83], v15 offset:0
  ds_read_b128 v[84:87], v15 offset:8192
  ds_read_b64_tr_b16 v[88:89], v16 offset:2048
  ds_read_b64_tr_b16 v[90:91], v16 offset:2560
  ds_read_b64_tr_b16 v[92:93], v17 offset:2048
  ds_read_b64_tr_b16 v[94:95], v17 offset:2560
  v_mfma_f32_32x32x16_bf16 v[192:207], v[32:35], v[40:43], v[192:207]
  v_mfma_f32_32x32x16_bf16 v[208:223], v[32:35], v[44:47], v[208:223]
  v_mfma_f32_32x32x16_bf16 v[224:239], v[36:39], v[40:43], v[224:239]
  v_mfma_f32_32x32x16_bf16 v[240:255], v[36:39], v[44:47], v[240:255]
  v_mfma_f32_32x32x16_bf16 v[192:207], v[48:51], v[56:59], v[192:207]
  v_mfma_f32_32x32x16_bf16 v[208:223], v[48:51], v[60:63], v[208:223]
  v_mfma_f32_32x32x16_bf16 v[224:239], v[52:55], v[56:59], v[224:239]
  v_mfma_f32_32x32x16_bf16 v[240:255], v[52:55], v[60:63], v[240:255]
  s_waitcnt lgkmcnt(0)
  s_barrier
  v_add_u32 v14, 32768, v14
  v_add_u32 v15, 32768, v15
  v_add_u32 v16, 32768, v16
  v_add_u32 v17, 32768, v17
  ds_read_b128 v[32:35], v14 offset:0
  ds_read_b128 v[36:39], v14 offset:8192
  ds_read_b64_tr_b16 v[40:41], v16 offset:0
  ds_read_b64_tr_b16 v[42:43], v16 offset:512
  ds_read_b64_tr_b16 v[44:45], v17 offset:0
  ds_read_b64_tr_b16 v[46:47], v17 offset:512
  ds_read_b128 v[48:51], v15 offset:0
  ds_read_b128 v[52:55], v15 offset:8192
  ds_read_b64_tr_b16 v[56:57], v16 offset:2048
  ds_read_b64_tr_b16 v[58:59], v16 offset:2560
  ds_read_b64_tr_b16 v[60:61], v17 offset:2048
  ds_read_b64_tr_b16 v[62:63], v17 offset:2560
  v_mfma_f32_32x32x16_bf16 v[192:207], v[64:67], v[72:75], v[192:207]
  v_mfma_f32_32x32x16_bf16 v[208:223], v[64:67], v[76:79], v[208:223]
  v_mfma_f32_32x32x16_bf16 v[224:239], v[68:71], v[72:75], v[224:239]
  v_mfma_f32_32x32x16_bf16 v[240:255], v[68:71], v[76:79], v[240:255]
  v_mfma_f32_32x32x16_bf16 v[192:207], v[80:83], v[88:91], v[192:207]
  v_mfma_f32_32x32x16_bf16 v[208:223], v[80:83], v[92:95], v[208:223]
  v_mfma_f32_32x32x16_bf16 v[224:239], v[84:87], v[88:91], v[224:239]
  v_mfma_f32_32x32x16_bf16 v[240:255], v[84:87], v[92:95], v[240:255]
  s_waitcnt lgkmcnt(0)
  s_barrier
  v_add_u32 v14, -131072, v14
  v_add_u32 v15, -131072, v15
  v_add_u32 v16, -131072, v16
  v_add_u32 v17, -131072, v17
  ds_read_b128 v[64:67], v14 offset:0
  ds_read_b128 v[68:71], v14 offset:8192
  ds_read_b64_tr_b16 v[72:73], v16 offset:0
  ds_read_b64_tr_b16 v[74:75], v16 offset:512
  ds_read_b64_tr_b16 v[76:77], v17 offset:0
  ds_read_b64_tr_b16 v[78:79], v17 offset:512
  ds_read_b128 v[80:83], v15 offset:0
  ds_read_b128 v[84:87], v15 offset:8192
  ds_read_b64_tr_b16 v[88:89], v16 offset:2048
  ds_read_b64_tr_b16 v[90:91], v16 offset:2560
  ds_read_b64_tr_b16 v[92:93], v17 offset:2048
  ds_read_b64_tr_b16 v[94:95], v17 offset:2560
  v_mfma_f32_32x32x16_bf16 v[192:207], v[32:35], v[40:43], v[192:207]
  v_mfma_f32_32x32x16_bf16 v[208:223], v[32:35], v[44:47], v[208:223]
  v_mfma_f32_32x32x16_bf16 v[224:239], v[36:39], v[40:43], v[224:239]
  v_mfma_f32_32x32x16_bf16 v[240:255], v[36:39], v[44:47], v[240:255]
  v_mfma_f32_32x32x16_bf16 v[192:207], v[48:51], v[56:59], v[192:207]
  v_mfma_f32_32x32x16_bf16 v[208:223], v[48:51], v[60:63], v[208:223]
  v_mfma_f32_32x32x16_bf16 v[224:239], v[52:55], v[56:59], v[224:239]
  v_mfma_f32_32x32x16_bf16 v[240:255], v[52:55], v[60:63], v[240:255]
  s_waitcnt lgkmcnt(0)
  s_barrier
  v_add_u32 v14, 32768, v14
  v_add_u32 v15, 32768, v15
  v_add_u32 v16, 32768, v16
  v_add_u32 v17, 32768, v17
  ds_read_b128 v[32:35], v14 offset:0
  ds_read_b128 v[36:39], v14 offset:8192
  ds_read_b64_tr_b16 v[40:41], v16 offset:0
  ds_read_b64_tr_b16 v[42:43], v16 offset:512
  ds_read_b64_tr_b16 v[44:45], v17 offset:0
  ds_read_b64_tr_b16 v[46:47], v17 offset:512
  ds_read_b128 v[48:51], v15 offset:0
  ds_read_b128 v[52:55], v15 offset:8192
  ds_read_b64_tr_b16 v[56:57], v16 offset:2048
  ds_read_b64_tr_b16 v[58:59], v16 offset:2560
  ds_read_b64_tr_b16 v[60:61], v17 offset:2048
  ds_read_b64_tr_b16 v[62:63], v17 offset:2560
  v_mfma_f32_32x32x16_bf16 v[192:207], v[64:67], v[72:75], v[192:207]
  v_mfma_f32_32x32x16_bf16 v[208:223], v[64:67], v[76:79], v[208:223]
  v_mfma_f32_32x32x16_bf16 v[224:239], v[68:71], v[72:75], v[224:239]
  v_mfma_f32_32x32x16_bf16 v[240:255], v[68:71], v[76:79], v[240:255]
  v_mfma_f32_32x32x16_bf16 v[192:207], v[80:83], v[88:91], v[192:207]
  v_mfma_f32_32x32x16_bf16 v[208:223], v[80:83], v[92:95], v[208:223]
  v_mfma_f32_32x32x16_bf16 v[224:239], v[84:87], v[88:91], v[224:239]
  v_mfma_f32_32x32x16_bf16 v[240:255], v[84:87], v[92:95], v[240:255]
  s_waitcnt lgkmcnt(0)
  s_barrier
  v_add_u32 v14, 32768, v14
  v_add_u32 v15, 32768, v15
  v_add_u32 v16, 32768, v16
  v_add_u32 v17, 32768, v17
  ds_read_b128 v[64:67], v14 offset:0
  ds_read_b128 v[68:71], v14 offset:8192
  ds_read_b64_tr_b16 v[72:73], v16 offset:0
  ds_read_b64_tr_b16 v[74:75], v16 offset:512
  ds_read_b64_tr_b16 v[76:77], v17 offset:0
  ds_read_b64_tr_b16 v[78:79], v17 offset:512
  ds_read_b128 v[80:83], v15 offset:0
  ds_read_b128 v[84:87], v15 offset:8192
  ds_read_b64_tr_b16 v[88:89], v16 offset:2048
  ds_read_b64_tr_b16 v[90:91], v16 offset:2560
  ds_read_b64_tr_b16 v[92:93], v17 offset:2048
  ds_read_b64_tr_b16 v[94:95], v17 offset:2560
  v_mfma_f32_32x32x16_bf16 v[192:207], v[32:35], v[40:43], v[192:207]
  v_mfma_f32_32x32x16_bf16 v[208:223], v[32:35], v[44:47], v[208:223]
  v_mfma_f32_32x32x16_bf16 v[224:239], v[36:39], v[40:43], v[224:239]
  v_mfma_f32_32x32x16_bf16 v[240:255], v[36:39], v[44:47], v[240:255]
  v_mfma_f32_32x32x16_bf16 v[192:207], v[48:51], v[56:59], v[192:207]
  v_mfma_f32_32x32x16_bf16 v[208:223], v[48:51], v[60:63], v[208:223]
  v_mfma_f32_32x32x16_bf16 v[224:239], v[52:55], v[56:59], v[224:239]
  v_mfma_f32_32x32x16_bf16 v[240:255], v[52:55], v[60:63], v[240:255]
  s_waitcnt lgkmcnt(0)
  s_barrier
  v_add_u32 v14, 32768, v14
  v_add_u32 v15, 32768, v15
  v_add_u32 v16, 32768, v16
  v_add_u32 v17, 32768, v17
  ds_read_b128 v[32:35], v14 offset:0
  ds_read_b128 v[36:39], v14 offset:8192
  ds_read_b64_tr_b16 v[40:41], v16 offset:0
  ds_read_b64_tr_b16 v[42:43], v16 offset:512
  ds_read_b64_tr_b16 v[44:45], v17 offset:0
  ds_read_b64_tr_b16 v[46:47], v17 offset:512
  ds_read_b128 v[48:51], v15 offset:0
  ds_read_b128 v[52:55], v15 offset:8192
  ds_read_b64_tr_b16 v[56:57], v16 offset:2048
  ds_read_b64_tr_b16 v[58:59], v16 offset:2560
  ds_read_b64_tr_b16 v[60:61], v17 offset:2048
  ds_read_b64_tr_b16 v[62:63], v17 offset:2560
  v_mfma_f32_32x32x16_bf16 v[192:207], v[64:67], v[72:75], v[192:207]
  v_mfma_f32_32x32x16_bf16 v[208:223], v[64:67], v[76:79], v[208:223]
  v_mfma_f32_32x32x16_bf16 v[224:239], v[68:71], v[72:75], v[224:239]
  v_mfma_f32_32x32x16_bf16 v[240:255], v[68:71], v[76:79], v[240:255]
  v_mfma_f32_32x32x16_bf16 v[192:207], v[80:83], v[88:91], v[192:207]
  v_mfma_f32_32x32x16_bf16 v[208:223], v[80:83], v[92:95], v[208:223]
  v_mfma_f32_32x32x16_bf16 v[224:239], v[84:87], v[88:91], v[224:239]
  v_mfma_f32_32x32x16_bf16 v[240:255], v[84:87], v[92:95], v[240:255]
  s_waitcnt lgkmcnt(0)
  s_barrier
  v_add_u32 v14, 32768, v14
  v_add_u32 v15, 32768, v15
  v_add_u32 v16, 32768, v16
  v_add_u32 v17, 32768, v17
  ds_read_b128 v[64:67], v14 offset:0
  ds_read_b128 v[68:71], v14 offset:8192
  ds_read_b64_tr_b16 v[72:73], v16 offset:0
  ds_read_b64_tr_b16 v[74:75], v16 offset:512
  ds_read_b64_tr_b16 v[76:77], v17 offset:0
  ds_read_b64_tr_b16 v[78:79], v17 offset:512
  ds_read_b128 v[80:83], v15 offset:0
  ds_read_b128 v[84:87], v15 offset:8192
  ds_read_b64_tr_b16 v[88:89], v16 offset:2048
  ds_read_b64_tr_b16 v[90:91], v16 offset:2560
  ds_read_b64_tr_b16 v[92:93], v17 offset:2048
  ds_read_b64_tr_b16 v[94:95], v17 offset:2560
  v_mfma_f32_32x32x16_bf16 v[192:207], v[32:35], v[40:43], v[192:207]
  v_mfma_f32_32x32x16_bf16 v[208:223], v[32:35], v[44:47], v[208:223]
  v_mfma_f32_32x32x16_bf16 v[224:239], v[36:39], v[40:43], v[224:239]
  v_mfma_f32_32x32x16_bf16 v[240:255], v[36:39], v[44:47], v[240:255]
  v_mfma_f32_32x32x16_bf16 v[192:207], v[48:51], v[56:59], v[192:207]
  v_mfma_f32_32x32x16_bf16 v[208:223], v[48:51], v[60:63], v[208:223]
  v_mfma_f32_32x32x16_bf16 v[224:239], v[52:55], v[56:59], v[224:239]
  v_mfma_f32_32x32x16_bf16 v[240:255], v[52:55], v[60:63], v[240:255]
  s_waitcnt lgkmcnt(0)
  s_barrier
  v_add_u32 v14, -131072, v14
  v_add_u32 v15, -131072, v15
  v_add_u32 v16, -131072, v16
  v_add_u32 v17, -131072, v17
  ds_read_b128 v[32:35], v14 offset:0
  ds_read_b128 v[36:39], v14 offset:8192
  ds_read_b64_tr_b16 v[40:41], v16 offset:0
  ds_read_b64_tr_b16 v[42:43], v16 offset:512
  ds_read_b64_tr_b16 v[44:45], v17 offset:0
  ds_read_b64_tr_b16 v[46:47], v17 offset:512
  ds_read_b128 v[48:51], v15 offset:0
  ds_read_b128 v[52:55], v15 offset:8192
  ds_read_b64_tr_b16 v[56:57], v16 offset:2048
  ds_read_b64_tr_b16 v[58:59], v16 offset:2560
  ds_read_b64_tr_b16 v[60:61], v17 offset:2048
  ds_read_b64_tr_b16 v[62:63], v17 offset:2560
  v_mfma_f32_32x32x16_bf16 v[192:207], v[64:67], v[72:75], v[192:207]
  v_mfma_f32_32x32x16_bf16 v[208:223], v[64:67], v[76:79], v[208:223]
  v_mfma_f32_32x32x16_bf16 v[224:239], v[68:71], v[72:75], v[224:239]
  v_mfma_f32_32x32x16_bf16 v[240:255], v[68:71], v[76:79], v[240:255]
  v_mfma_f32_32x32x16_bf16 v[192:207], v[80:83], v[88:91], v[192:207]
  v_mfma_f32_32x32x16_bf16 v[208:223], v[80:83], v[92:95], v[208:223]
  v_mfma_f32_32x32x16_bf16 v[224:239], v[84:87], v[88:91], v[224:239]
  v_mfma_f32_32x32x16_bf16 v[240:255], v[84:87], v[92:95], v[240:255]
  s_waitcnt lgkmcnt(0)
  s_barrier
  v_add_u32 v14, 32768, v14
  v_add_u32 v15, 32768, v15
  v_add_u32 v16, 32768, v16
  v_add_u32 v17, 32768, v17
  ds_read_b128 v[64:67], v14 offset:0
  ds_read_b128 v[68:71], v14 offset:8192
  ds_read_b64_tr_b16 v[72:73], v16 offset:0
  ds_read_b64_tr_b16 v[74:75], v16 offset:512
  ds_read_b64_tr_b16 v[76:77], v17 offset:0
  ds_read_b64_tr_b16 v[78:79], v17 offset:512
  ds_read_b128 v[80:83], v15 offset:0
  ds_read_b128 v[84:87], v15 offset:8192
  ds_read_b64_tr_b16 v[88:89], v16 offset:2048
  ds_read_b64_tr_b16 v[90:91], v16 offset:2560
  ds_read_b64_tr_b16 v[92:93], v17 offset:2048
  ds_read_b64_tr_b16 v[94:95], v17 offset:2560
  v_mfma_f32_32x32x16_bf16 v[192:207], v[32:35], v[40:43], v[192:207]
  v_mfma_f32_32x32x16_bf16 v[208:223], v[32:35], v[44:47], v[208:223]
  v_mfma_f32_32x32x16_bf16 v[224:239], v[36:39], v[40:43], v[224:239]
  v_mfma_f32_32x32x16_bf16 v[240:255], v[36:39], v[44:47], v[240:255]
  v_mfma_f32_32x32x16_bf16 v[192:207], v[48:51], v[56:59], v[192:207]
  v_mfma_f32_32x32x16_bf16 v[208:223], v[48:51], v[60:63], v[208:223]
  v_mfma_f32_32x32x16_bf16 v[224:239], v[52:55], v[56:59], v[224:239]
  v_mfma_f32_32x32x16_bf16 v[240:255], v[52:55], v[60:63], v[240:255]
  s_waitcnt lgkmcnt(0)
  v_mfma_f32_32x32x16_bf16 v[192:207], v[64:67], v[72:75], v[192:207]
  v_mfma_f32_32x32x16_bf16 v[208:223], v[64:67], v[76:79], v[208:223]
  v_mfma_f32_32x32x16_bf16 v[224:239], v[68:71], v[72:75], v[224:239]
  v_mfma_f32_32x32x16_bf16 v[240:255], v[68:71], v[76:79], v[240:255]
  v_mfma_f32_32x32x16_bf16 v[192:207], v[80:83], v[88:91], v[192:207]
  v_mfma_f32_32x32x16_bf16 v[208:223], v[80:83], v[92:95], v[208:223]
  v_mfma_f32_32x32x16_bf16 v[224:239], v[84:87], v[88:91], v[224:239]
  v_mfma_f32_32x32x16_bf16 v[240:255], v[84:87], v[92:95], v[240:255]
  s_nop 7
  s_nop 7
  s_nop 7
  s_barrier
  v_lshrrev_b32 v5, 5, v1
  v_lshlrev_b32 v5, 10, v5
  v_and_b32 v6, 31, v1
  v_lshl_add_u32 v5, v6, 2, v5
  s_lshl_b32 s47, s34, 15
  v_add_u32 v5, s47, v5
  ds_write_b32 v5, v128 offset:0
  ds_write_b32 v5, v129 offset:256
  ds_write_b32 v5, v130 offset:512
  ds_write_b32 v5, v131 offset:768
  ds_write_b32 v5, v132 offset:2048
  ds_write_b32 v5, v133 offset:2304
  ds_write_b32 v5, v134 offset:2560
  ds_write_b32 v5, v135 offset:2816
  ds_write_b32 v5, v136 offset:4096
  ds_write_b32 v5, v137 offset:4352
  ds_write_b32 v5, v138 offset:4608
  ds_write_b32 v5, v139 offset:4864
  ds_write_b32 v5, v140 offset:6144
  ds_write_b32 v5, v141 offset:6400
  ds_write_b32 v5, v142 offset:6656
  ds_write_b32 v5, v143 offset:6912
  ds_write_b32 v5, v144 offset:128
  ds_write_b32 v5, v145 offset:384
  ds_write_b32 v5, v146 offset:640
  ds_write_b32 v5, v147 offset:896
  ds_write_b32 v5, v148 offset:2176
  ds_write_b32 v5, v149 offset:2432
  ds_write_b32 v5, v150 offset:2688
  ds_write_b32 v5, v151 offset:2944
  ds_write_b32 v5, v152 offset:4224
  ds_write_b32 v5, v153 offset:4480
  ds_write_b32 v5, v154 offset:4736
  ds_write_b32 v5, v155 offset:4992
  ds_write_b32 v5, v156 offset:6272
  ds_write_b32 v5, v157 offset:6528
  ds_write_b32 v5, v158 offset:6784
  ds_write_b32 v5, v159 offset:7040
  ds_write_b32 v5, v160 offset:8192
  ds_write_b32 v5, v161 offset:8448
  ds_write_b32 v5, v162 offset:8704
  ds_write_b32 v5, v163 offset:8960
  ds_write_b32 v5, v164 offset:10240
  ds_write_b32 v5, v165 offset:10496
  ds_write_b32 v5, v166 offset:10752
  ds_write_b32 v5, v167 offset:11008
  ds_write_b32 v5, v168 offset:12288
  ds_write_b32 v5, v169 offset:12544
  ds_write_b32 v5, v170 offset:12800
  ds_write_b32 v5, v171 offset:13056
  ds_write_b32 v5, v172 offset:14336
  ds_write_b32 v5, v173 offset:14592
  ds_write_b32 v5, v174 offset:14848
  ds_write_b32 v5, v175 offset:15104
  ds_write_b32 v5, v176 offset:8320
  ds_write_b32 v5, v177 offset:8576
  ds_write_b32 v5, v178 offset:8832
  ds_write_b32 v5, v179 offset:9088
  ds_write_b32 v5, v180 offset:10368
  ds_write_b32 v5, v181 offset:10624
  ds_write_b32 v5, v182 offset:10880
  ds_write_b32 v5, v183 offset:11136
  ds_write_b32 v5, v184 offset:12416
  ds_write_b32 v5, v185 offset:12672
  ds_write_b32 v5, v186 offset:12928
  ds_write_b32 v5, v187 offset:13184
  ds_write_b32 v5, v188 offset:14464
  ds_write_b32 v5, v189 offset:14720
  ds_write_b32 v5, v190 offset:14976
  ds_write_b32 v5, v191 offset:15232
  ds_write_b32 v5, v192 offset:16384
  ds_write_b32 v5, v193 offset:16640
  ds_write_b32 v5, v194 offset:16896
  ds_write_b32 v5, v195 offset:17152
  ds_write_b32 v5, v196 offset:18432
  ds_write_b32 v5, v197 offset:18688
  ds_write_b32 v5, v198 offset:18944
  ds_write_b32 v5, v199 offset:19200
  ds_write_b32 v5, v200 offset:20480
  ds_write_b32 v5, v201 offset:20736
  ds_write_b32 v5, v202 offset:20992
  ds_write_b32 v5, v203 offset:21248
  ds_write_b32 v5, v204 offset:22528
  ds_write_b32 v5, v205 offset:22784
  ds_write_b32 v5, v206 offset:23040
  ds_write_b32 v5, v207 offset:23296
  ds_write_b32 v5, v208 offset:16512
  ds_write_b32 v5, v209 offset:16768
  ds_write_b32 v5, v210 offset:17024
  ds_write_b32 v5, v211 offset:17280
  ds_write_b32 v5, v212 offset:18560
  ds_write_b32 v5, v213 offset:18816
  ds_write_b32 v5, v214 offset:19072
  ds_write_b32 v5, v215 offset:19328
  ds_write_b32 v5, v216 offset:20608
  ds_write_b32 v5, v217 offset:20864
  ds_write_b32 v5, v218 offset:21120
  ds_write_b32 v5, v219 offset:21376
  ds_write_b32 v5, v220 offset:22656
  ds_write_b32 v5, v221 offset:22912
  ds_write_b32 v5, v222 offset:23168
  ds_write_b32 v5, v223 offset:23424
  ds_write_b32 v5, v224 offset:24576
  ds_write_b32 v5, v225 offset:24832
  ds_write_b32 v5, v226 offset:25088
  ds_write_b32 v5, v227 offset:25344
  ds_write_b32 v5, v228 offset:26624
  ds_write_b32 v5, v229 offset:26880
  ds_write_b32 v5, v230 offset:27136
  ds_write_b32 v5, v231 offset:27392
  ds_write_b32 v5, v232 offset:28672
  ds_write_b32 v5, v233 offset:28928
  ds_write_b32 v5, v234 offset:29184
  ds_write_b32 v5, v235 offset:29440
  ds_write_b32 v5, v236 offset:30720
  ds_write_b32 v5, v237 offset:30976
  ds_write_b32 v5, v238 offset:31232
  ds_write_b32 v5, v239 offset:31488
  ds_write_b32 v5, v240 offset:24704
  ds_write_b32 v5, v241 offset:24960
  ds_write_b32 v5, v242 offset:25216
  ds_write_b32 v5, v243 offset:25472
  ds_write_b32 v5, v244 offset:26752
  ds_write_b32 v5, v245 offset:27008
  ds_write_b32 v5, v246 offset:27264
  ds_write_b32 v5, v247 offset:27520
  ds_write_b32 v5, v248 offset:28800
  ds_write_b32 v5, v249 offset:29056
  ds_write_b32 v5, v250 offset:29312
  ds_write_b32 v5, v251 offset:29568
  ds_write_b32 v5, v252 offset:30848
  ds_write_b32 v5, v253 offset:31104
  ds_write_b32 v5, v254 offset:31360
  ds_write_b32 v5, v255 offset:31616
  s_waitcnt lgkmcnt(0)
  s_barrier
  v_lshrrev_b32 v2, 2, v0
  v_and_b32 v3, 3, v0
  v_lshlrev_b32 v5, 6, v3
  v_lshl_add_u32 v5, v2, 8, v5
  ds_read_b128 v[32:35], v5 offset:0
  ds_read_b128 v[36:39], v5 offset:16
  ds_read_b128 v[40:43], v5 offset:32
  ds_read_b128 v[44:47], v5 offset:48
  ds_read_b128 v[48:51], v5 offset:16384
  ds_read_b128 v[52:55], v5 offset:16400
  ds_read_b128 v[56:59], v5 offset:16416
  ds_read_b128 v[60:63], v5 offset:16432
  ds_read_b128 v[64:67], v5 offset:32768
  ds_read_b128 v[68:71], v5 offset:32784
  ds_read_b128 v[72:75], v5 offset:32800
  ds_read_b128 v[76:79], v5 offset:32816
  ds_read_b128 v[80:83], v5 offset:49152
  ds_read_b128 v[84:87], v5 offset:49168
  ds_read_b128 v[88:91], v5 offset:49184
  ds_read_b128 v[92:95], v5 offset:49200
  s_waitcnt lgkmcnt(0)
  v_add_f32 v32, v32, v64
  v_add_f32 v33, v33, v65
  v_add_f32 v34, v34, v66
  v_add_f32 v35, v35, v67
  v_add_f32 v36, v36, v68
  v_add_f32 v37, v37, v69
  v_add_f32 v38, v38, v70
  v_add_f32 v39, v39, v71
  v_add_f32 v40, v40, v72
  v_add_f32 v41, v41, v73
  v_add_f32 v42, v42, v74
  v_add_f32 v43, v43, v75
  v_add_f32 v44, v44, v76
  v_add_f32 v45, v45, v77
  v_add_f32 v46, v46, v78
  v_add_f32 v47, v47, v79
  v_add_f32 v48, v48, v80
  v_add_f32 v49, v49, v81
  v_add_f32 v50, v50, v82
  v_add_f32 v51, v51, v83
  v_add_f32 v52, v52, v84
  v_add_f32 v53, v53, v85
  v_add_f32 v54, v54, v86
  v_add_f32 v55, v55, v87
  v_add_f32 v56, v56, v88
  v_add_f32 v57, v57, v89
  v_add_f32 v58, v58, v90
  v_add_f32 v59, v59, v91
  v_add_f32 v60, v60, v92
  v_add_f32 v61, v61, v93
  v_add_f32 v62, v62, v94
  v_add_f32 v63, v63, v95
  v_add_u32 v8, 65536, v5
  ds_read_b128 v[64:67], v8
  v_add_u32 v8, 65552, v5
  ds_read_b128 v[68:71], v8
  v_add_u32 v8, 65568, v5
  ds_read_b128 v[72:75], v8
  v_add_u32 v8, 65584, v5
  ds_read_b128 v[76:79], v8
  v_add_u32 v8, 81920, v5
  ds_read_b128 v[80:83], v8
  v_add_u32 v8, 81936, v5
  ds_read_b128 v[84:87], v8
  v_add_u32 v8, 81952, v5
  ds_read_b128 v[88:91], v8
  v_add_u32 v8, 81968, v5
  ds_read_b128 v[92:95], v8
  s_waitcnt lgkmcnt(0)
  v_add_f32 v32, v32, v64
  v_add_f32 v33, v33, v65
  v_add_f32 v34, v34, v66
  v_add_f32 v35, v35, v67
  v_add_f32 v36, v36, v68
  v_add_f32 v37, v37, v69
  v_add_f32 v38, v38, v70
  v_add_f32 v39, v39, v71
  v_add_f32 v40, v40, v72
  v_add_f32 v41, v41, v73
  v_add_f32 v42, v42, v74
  v_add_f32 v43, v43, v75
  v_add_f32 v44, v44, v76
  v_add_f32 v45, v45, v77
  v_add_f32 v46, v46, v78
  v_add_f32 v47, v47, v79
  v_add_f32 v48, v48, v80
  v_add_f32 v49, v49, v81
  v_add_f32 v50, v50, v82
  v_add_f32 v51, v51, v83
  v_add_f32 v52, v52, v84
  v_add_f32 v53, v53, v85
  v_add_f32 v54, v54, v86
  v_add_f32 v55, v55, v87
  v_add_f32 v56, v56, v88
  v_add_f32 v57, v57, v89
  v_add_f32 v58, v58, v90
  v_add_f32 v59, v59, v91
  v_add_f32 v60, v60, v92
  v_add_f32 v61, v61, v93
  v_add_f32 v62, v62, v94
  v_add_f32 v63, v63, v95
  v_add_u32 v8, 98304, v5
  ds_read_b128 v[64:67], v8
  v_add_u32 v8, 98320, v5
  ds_read_b128 v[68:71], v8
  v_add_u32 v8, 98336, v5
  ds_read_b128 v[72:75], v8
  v_add_u32 v8, 98352, v5
  ds_read_b128 v[76:79], v8
  v_add_u32 v8, 114688, v5
  ds_read_b128 v[80:83], v8
  v_add_u32 v8, 114704, v5
  ds_read_b128 v[84:87], v8
  v_add_u32 v8, 114720, v5
  ds_read_b128 v[88:91], v8
  v_add_u32 v8, 114736, v5
  ds_read_b128 v[92:95], v8
  s_waitcnt lgkmcnt(0)
  v_add_f32 v32, v32, v64
  v_add_f32 v33, v33, v65
  v_add_f32 v34, v34, v66
  v_add_f32 v35, v35, v67
  v_add_f32 v36, v36, v68
  v_add_f32 v37, v37, v69
  v_add_f32 v38, v38, v70
  v_add_f32 v39, v39, v71
  v_add_f32 v40, v40, v72
  v_add_f32 v41, v41, v73
  v_add_f32 v42, v42, v74
  v_add_f32 v43, v43, v75
  v_add_f32 v44, v44, v76
  v_add_f32 v45, v45, v77
  v_add_f32 v46, v46, v78
  v_add_f32 v47, v47, v79
  v_add_f32 v48, v48, v80
  v_add_f32 v49, v49, v81
  v_add_f32 v50, v50, v82
  v_add_f32 v51, v51, v83
  v_add_f32 v52, v52, v84
  v_add_f32 v53, v53, v85
  v_add_f32 v54, v54, v86
  v_add_f32 v55, v55, v87
  v_add_f32 v56, v56, v88
  v_add_f32 v57, v57, v89
  v_add_f32 v58, v58, v90
  v_add_f32 v59, v59, v91
  v_add_f32 v60, v60, v92
  v_add_f32 v61, v61, v93
  v_add_f32 v62, v62, v94
  v_add_f32 v63, v63, v95
  s_waitcnt vmcnt(0)
  v_sub_f32 v121, 1.0, v120
  v_cvt_pk_bf16_f32 v121, v121, v121
  v_lshlrev_b32 v121, 16, v121
  v_lshlrev_b32 v64, 16, v96
  v_lshlrev_b32 v80, 16, v104
  v_lshlrev_b32 v122, 16, v112
  v_and_b32 v65, 0xffff0000, v96
  v_and_b32 v81, 0xffff0000, v104
  v_and_b32 v123, 0xffff0000, v112
  v_lshlrev_b32 v66, 16, v97
  v_lshlrev_b32 v82, 16, v105
  v_lshlrev_b32 v124, 16, v113
  v_and_b32 v67, 0xffff0000, v97
  v_and_b32 v83, 0xffff0000, v105
  v_and_b32 v125, 0xffff0000, v113
  v_mul_f32 v64, v64, v80
  v_mul_f32 v65, v65, v81
  v_mul_f32 v66, v66, v82
  v_mul_f32 v67, v67, v83
  v_cvt_pk_bf16_f32 v64, v64, v64
  v_cvt_pk_bf16_f32 v65, v65, v65
  v_cvt_pk_bf16_f32 v66, v66, v66
  v_cvt_pk_bf16_f32 v67, v67, v67
  v_lshlrev_b32 v64, 16, v64
  v_lshlrev_b32 v65, 16, v65
  v_lshlrev_b32 v66, 16, v66
  v_lshlrev_b32 v67, 16, v67
  v_fma_f32 v64, 2.0, v32, v64
  v_fma_f32 v65, 2.0, v33, v65
  v_fma_f32 v66, 2.0, v34, v66
  v_fma_f32 v67, 2.0, v35, v67
  v_mul_f32 v64, v64, v120
  v_mul_f32 v65, v65, v120
  v_mul_f32 v66, v66, v120
  v_mul_f32 v67, v67, v120
  v_cvt_pk_bf16_f32 v48, v48, v48
  v_cvt_pk_bf16_f32 v49, v49, v49
  v_cvt_pk_bf16_f32 v50, v50, v50
  v_cvt_pk_bf16_f32 v51, v51, v51
  v_lshlrev_b32 v48, 16, v48
  v_lshlrev_b32 v49, 16, v49
  v_lshlrev_b32 v50, 16, v50
  v_lshlrev_b32 v51, 16, v51
  v_add_f32 v48, v48, v122
  v_add_f32 v49, v49, v123
  v_add_f32 v50, v50, v124
  v_add_f32 v51, v51, v125
  v_cvt_pk_bf16_f32 v48, v48, v48
  v_cvt_pk_bf16_f32 v49, v49, v49
  v_cvt_pk_bf16_f32 v50, v50, v50
  v_cvt_pk_bf16_f32 v51, v51, v51
  v_lshlrev_b32 v48, 16, v48
  v_lshlrev_b32 v49, 16, v49
  v_lshlrev_b32 v50, 16, v50
  v_lshlrev_b32 v51, 16, v51
  v_mul_f32 v48, v48, v121
  v_mul_f32 v49, v49, v121
  v_mul_f32 v50, v50, v121
  v_mul_f32 v51, v51, v121
  v_cvt_pk_bf16_f32 v48, v48, v48
  v_cvt_pk_bf16_f32 v49, v49, v49
  v_cvt_pk_bf16_f32 v50, v50, v50
  v_cvt_pk_bf16_f32 v51, v51, v51
  v_lshlrev_b32 v48, 16, v48
  v_lshlrev_b32 v49, 16, v49
  v_lshlrev_b32 v50, 16, v50
  v_lshlrev_b32 v51, 16, v51
  v_add_f32 v32, v64, v48
  v_add_f32 v33, v65, v49
  v_add_f32 v34, v66, v50
  v_add_f32 v35, v67, v51
  v_lshlrev_b32 v68, 16, v98
  v_lshlrev_b32 v84, 16, v106
  v_lshlrev_b32 v122, 16, v114
  v_and_b32 v69, 0xffff0000, v98
  v_and_b32 v85, 0xffff0000, v106
  v_and_b32 v123, 0xffff0000, v114
  v_lshlrev_b32 v70, 16, v99
  v_lshlrev_b32 v86, 16, v107
  v_lshlrev_b32 v124, 16, v115
  v_and_b32 v71, 0xffff0000, v99
  v_and_b32 v87, 0xffff0000, v107
  v_and_b32 v125, 0xffff0000, v115
  v_mul_f32 v68, v68, v84
  v_mul_f32 v69, v69, v85
  v_mul_f32 v70, v70, v86
  v_mul_f32 v71, v71, v87
  v_cvt_pk_bf16_f32 v68, v68, v68
  v_cvt_pk_bf16_f32 v69, v69, v69
  v_cvt_pk_bf16_f32 v70, v70, v70
  v_cvt_pk_bf16_f32 v71, v71, v71
  v_lshlrev_b32 v68, 16, v68
  v_lshlrev_b32 v69, 16, v69
  v_lshlrev_b32 v70, 16, v70
  v_lshlrev_b32 v71, 16, v71
  v_fma_f32 v68, 2.0, v36, v68
  v_fma_f32 v69, 2.0, v37, v69
  v_fma_f32 v70, 2.0, v38, v70
  v_fma_f32 v71, 2.0, v39, v71
  v_mul_f32 v68, v68, v120
  v_mul_f32 v69, v69, v120
  v_mul_f32 v70, v70, v120
  v_mul_f32 v71, v71, v120
  v_cvt_pk_bf16_f32 v52, v52, v52
  v_cvt_pk_bf16_f32 v53, v53, v53
  v_cvt_pk_bf16_f32 v54, v54, v54
  v_cvt_pk_bf16_f32 v55, v55, v55
  v_lshlrev_b32 v52, 16, v52
  v_lshlrev_b32 v53, 16, v53
  v_lshlrev_b32 v54, 16, v54
  v_lshlrev_b32 v55, 16, v55
  v_add_f32 v52, v52, v122
  v_add_f32 v53, v53, v123
  v_add_f32 v54, v54, v124
  v_add_f32 v55, v55, v125
  v_cvt_pk_bf16_f32 v52, v52, v52
  v_cvt_pk_bf16_f32 v53, v53, v53
  v_cvt_pk_bf16_f32 v54, v54, v54
  v_cvt_pk_bf16_f32 v55, v55, v55
  v_lshlrev_b32 v52, 16, v52
  v_lshlrev_b32 v53, 16, v53
  v_lshlrev_b32 v54, 16, v54
  v_lshlrev_b32 v55, 16, v55
  v_mul_f32 v52, v52, v121
  v_mul_f32 v53, v53, v121
  v_mul_f32 v54, v54, v121
  v_mul_f32 v55, v55, v121
  v_cvt_pk_bf16_f32 v52, v52, v52
  v_cvt_pk_bf16_f32 v53, v53, v53
  v_cvt_pk_bf16_f32 v54, v54, v54
  v_cvt_pk_bf16_f32 v55, v55, v55
  v_lshlrev_b32 v52, 16, v52
  v_lshlrev_b32 v53, 16, v53
  v_lshlrev_b32 v54, 16, v54
  v_lshlrev_b32 v55, 16, v55
  v_add_f32 v36, v68, v52
  v_add_f32 v37, v69, v53
  v_add_f32 v38, v70, v54
  v_add_f32 v39, v71, v55
  v_lshlrev_b32 v72, 16, v100
  v_lshlrev_b32 v88, 16, v108
  v_lshlrev_b32 v122, 16, v116
  v_and_b32 v73, 0xffff0000, v100
  v_and_b32 v89, 0xffff0000, v108
  v_and_b32 v123, 0xffff0000, v116
  v_lshlrev_b32 v74, 16, v101
  v_lshlrev_b32 v90, 16, v109
  v_lshlrev_b32 v124, 16, v117
  v_and_b32 v75, 0xffff0000, v101
  v_and_b32 v91, 0xffff0000, v109
  v_and_b32 v125, 0xffff0000, v117
  v_mul_f32 v72, v72, v88
  v_mul_f32 v73, v73, v89
  v_mul_f32 v74, v74, v90
  v_mul_f32 v75, v75, v91
  v_cvt_pk_bf16_f32 v72, v72, v72
  v_cvt_pk_bf16_f32 v73, v73, v73
  v_cvt_pk_bf16_f32 v74, v74, v74
  v_cvt_pk_bf16_f32 v75, v75, v75
  v_lshlrev_b32 v72, 16, v72
  v_lshlrev_b32 v73, 16, v73
  v_lshlrev_b32 v74, 16, v74
  v_lshlrev_b32 v75, 16, v75
  v_fma_f32 v72, 2.0, v40, v72
  v_fma_f32 v73, 2.0, v41, v73
  v_fma_f32 v74, 2.0, v42, v74
  v_fma_f32 v75, 2.0, v43, v75
  v_mul_f32 v72, v72, v120
  v_mul_f32 v73, v73, v120
  v_mul_f32 v74, v74, v120
  v_mul_f32 v75, v75, v120
  v_cvt_pk_bf16_f32 v56, v56, v56
  v_cvt_pk_bf16_f32 v57, v57, v57
  v_cvt_pk_bf16_f32 v58, v58, v58
  v_cvt_pk_bf16_f32 v59, v59, v59
  v_lshlrev_b32 v56, 16, v56
  v_lshlrev_b32 v57, 16, v57
  v_lshlrev_b32 v58, 16, v58
  v_lshlrev_b32 v59, 16, v59
  v_add_f32 v56, v56, v122
  v_add_f32 v57, v57, v123
  v_add_f32 v58, v58, v124
  v_add_f32 v59, v59, v125
  v_cvt_pk_bf16_f32 v56, v56, v56
  v_cvt_pk_bf16_f32 v57, v57, v57
  v_cvt_pk_bf16_f32 v58, v58, v58
  v_cvt_pk_bf16_f32 v59, v59, v59
  v_lshlrev_b32 v56, 16, v56
  v_lshlrev_b32 v57, 16, v57
  v_lshlrev_b32 v58, 16, v58
  v_lshlrev_b32 v59, 16, v59
  v_mul_f32 v56, v56, v121
  v_mul_f32 v57, v57, v121
  v_mul_f32 v58, v58, v121
  v_mul_f32 v59, v59, v121
  v_cvt_pk_bf16_f32 v56, v56, v56
  v_cvt_pk_bf16_f32 v57, v57, v57
  v_cvt_pk_bf16_f32 v58, v58, v58
  v_cvt_pk_bf16_f32 v59, v59, v59
  v_lshlrev_b32 v56, 16, v56
  v_lshlrev_b32 v57, 16, v57
  v_lshlrev_b32 v58, 16, v58
  v_lshlrev_b32 v59, 16, v59
  v_add_f32 v40, v72, v56
  v_add_f32 v41, v73, v57
  v_add_f32 v42, v74, v58
  v_add_f32 v43, v75, v59
  v_lshlrev_b32 v76, 16, v102
  v_lshlrev_b32 v92, 16, v110
  v_lshlrev_b32 v122, 16, v118
  v_and_b32 v77, 0xffff0000, v102
  v_and_b32 v93, 0xffff0000, v110
  v_and_b32 v123, 0xffff0000, v118
  v_lshlrev_b32 v78, 16, v103
  v_lshlrev_b32 v94, 16, v111
  v_lshlrev_b32 v124, 16, v119
  v_and_b32 v79, 0xffff0000, v103
  v_and_b32 v95, 0xffff0000, v111
  v_and_b32 v125, 0xffff0000, v119
  v_mul_f32 v76, v76, v92
  v_mul_f32 v77, v77, v93
  v_mul_f32 v78, v78, v94
  v_mul_f32 v79, v79, v95
  v_cvt_pk_bf16_f32 v76, v76, v76
  v_cvt_pk_bf16_f32 v77, v77, v77
  v_cvt_pk_bf16_f32 v78, v78, v78
  v_cvt_pk_bf16_f32 v79, v79, v79
  v_lshlrev_b32 v76, 16, v76
  v_lshlrev_b32 v77, 16, v77
  v_lshlrev_b32 v78, 16, v78
  v_lshlrev_b32 v79, 16, v79
  v_fma_f32 v76, 2.0, v44, v76
  v_fma_f32 v77, 2.0, v45, v77
  v_fma_f32 v78, 2.0, v46, v78
  v_fma_f32 v79, 2.0, v47, v79
  v_mul_f32 v76, v76, v120
  v_mul_f32 v77, v77, v120
  v_mul_f32 v78, v78, v120
  v_mul_f32 v79, v79, v120
  v_cvt_pk_bf16_f32 v60, v60, v60
  v_cvt_pk_bf16_f32 v61, v61, v61
  v_cvt_pk_bf16_f32 v62, v62, v62
  v_cvt_pk_bf16_f32 v63, v63, v63
  v_lshlrev_b32 v60, 16, v60
  v_lshlrev_b32 v61, 16, v61
  v_lshlrev_b32 v62, 16, v62
  v_lshlrev_b32 v63, 16, v63
  v_add_f32 v60, v60, v122
  v_add_f32 v61, v61, v123
  v_add_f32 v62, v62, v124
  v_add_f32 v63, v63, v125
  v_cvt_pk_bf16_f32 v60, v60, v60
  v_cvt_pk_bf16_f32 v61, v61, v61
  v_cvt_pk_bf16_f32 v62, v62, v62
  v_cvt_pk_bf16_f32 v63, v63, v63
  v_lshlrev_b32 v60, 16, v60
  v_lshlrev_b32 v61, 16, v61
  v_lshlrev_b32 v62, 16, v62
  v_lshlrev_b32 v63, 16, v63
  v_mul_f32 v60, v60, v121
  v_mul_f32 v61, v61, v121
  v_mul_f32 v62, v62, v121
  v_mul_f32 v63, v63, v121
  v_cvt_pk_bf16_f32 v60, v60, v60
  v_cvt_pk_bf16_f32 v61, v61, v61
  v_cvt_pk_bf16_f32 v62, v62, v62
  v_cvt_pk_bf16_f32 v63, v63, v63
  v_lshlrev_b32 v60, 16, v60
  v_lshlrev_b32 v61, 16, v61
  v_lshlrev_b32 v62, 16, v62
  v_lshlrev_b32 v63, 16, v63
  v_add_f32 v44, v76, v60
  v_add_f32 v45, v77, v61
  v_add_f32 v46, v78, v62
  v_add_f32 v47, v79, v63
  v_lshlrev_b32 v5, 6, v3
  v_lshl_add_u32 v5, v2, 11, v5
  s_lshl_b32 s47, s35, 17
  s_lshl_b32 s48, s36, 8
  s_add_u32 s47, s47, s48
  buffer_store_dwordx4 v[32:35], v5, s[16:19], s47 offen offset:0
  buffer_store_dwordx4 v[36:39], v5, s[16:19], s47 offen offset:16
  buffer_store_dwordx4 v[40:43], v5, s[16:19], s47 offen offset:32
  buffer_store_dwordx4 v[44:47], v5, s[16:19], s47 offen offset:48
K3_END:
  s_endpgm
.section .rodata,"a"
.p2align 6
.amdhsa_kernel k1_kernel
  .amdhsa_next_free_vgpr 232
  .amdhsa_next_free_sgpr 96
  .amdhsa_accum_offset 232
  .amdhsa_group_segment_fixed_size 0
  .amdhsa_kernarg_size 144
  .amdhsa_user_sgpr_count 2
  .amdhsa_user_sgpr_kernarg_segment_ptr 1
  .amdhsa_system_sgpr_workgroup_id_x 1
.end_amdhsa_kernel
.text
.section .rodata,"a"
.p2align 6
.amdhsa_kernel k2_kernel
  .amdhsa_next_free_vgpr 160
  .amdhsa_next_free_sgpr 96
  .amdhsa_accum_offset 160
  .amdhsa_group_segment_fixed_size 0
  .amdhsa_kernarg_size 144
  .amdhsa_user_sgpr_count 2
  .amdhsa_user_sgpr_kernarg_segment_ptr 1
  .amdhsa_system_sgpr_workgroup_id_x 1
.end_amdhsa_kernel
.text
.section .rodata,"a"
.p2align 6
.amdhsa_kernel k3_kernel
  .amdhsa_next_free_vgpr 256
  .amdhsa_next_free_sgpr 96
  .amdhsa_accum_offset 256
  .amdhsa_group_segment_fixed_size 0
  .amdhsa_kernarg_size 144
  .amdhsa_user_sgpr_count 2
  .amdhsa_user_sgpr_kernarg_segment_ptr 1
  .amdhsa_system_sgpr_workgroup_id_x 1
.end_amdhsa_kernel
.text
```
